```python
import torch

def _softmax(x, axis=-1):
    return torch.softmax(x, dim=axis)

def _gelu(x):
    return torch.nn.functional.gelu(x, approximate='tanh')

def _silu(x):
    return torch.nn.functional.silu(x)

def _sigmoid(x):
    return torch.sigmoid(x)

def _layernorm(x, axis=-1, eps=1e-05):
    m = x.mean(dim=axis, keepdim=True)
    v = x.var(dim=axis, keepdim=True, unbiased=False)
    return (x - m) / torch.sqrt(v + eps)

def _scatter_add(tgt, idx, src, axis=0):
    return tgt.clone().index_add_(axis, idx, src)

def _segment_sum(src, seg, n):
    out = torch.zeros((n,) + src.shape[1:], dtype=src.dtype)
    return out.index_add_(0, seg, src)

def _pad(x, pw):
    flat = tuple((v for pair in reversed(pw) for v in pair))
    return torch.nn.functional.pad(x, flat)
kernel_name = 'adaLN_cond__sliding_block_cached__swiglu_ffn__decode'

def setup_inputs():

    _w = lambda a: (lambda t: t.to(torch.bfloat16) if t.is_floating_point() else t)(torch.as_tensor(a))

    def _A_setup():
        B, Sq, D = (2, 1, 448)
        Hq, Hkv, Sk, Dh = (16, 8, 32768, 256)
        assert Hq % Hkv == 0, (Hq, Hkv)
        return {'x': _w((lambda *s: torch.randn(*s, dtype=torch.bfloat16) * 0.05)(B, Sq, D)), 'k_cache': _w((lambda *s: torch.randn(*s, dtype=torch.bfloat16) * 3.2)(B, Hkv, Sk, Dh)), 'v_cache': _w((lambda *s: torch.randn(*s, dtype=torch.bfloat16) * 0.4)(B, Hkv, Sk, Dh)), 'wq': _w((lambda *s: torch.randn(*s, dtype=torch.bfloat16) * 3.2)(D, Hq * Dh) * D ** (-0.5)), 'wo': _w((lambda *s: torch.randn(*s, dtype=torch.bfloat16) * 0.4)(Hq * Dh, D) * (Hq * Dh) ** (-0.5))}
    _A_in = _A_setup()

    def _B_setup():
        B, S, D, F = (2, 1, 448, 1792)
        return {'x': _w((lambda *s: torch.randn(*s, dtype=torch.bfloat16) * 0.05)(B, S, D)), 'w_gate': _w((lambda *s: torch.randn(*s, dtype=torch.bfloat16) * 0.05)(D, F)), 'w_up': _w((lambda *s: torch.randn(*s, dtype=torch.bfloat16) * 0.05)(D, F)), 'w_down': _w((lambda *s: torch.randn(*s, dtype=torch.bfloat16) * 0.05)(F, D))}
    _B_in = _B_setup()
    return {'A_x': _A_in['x'], 'A_k_cache': _A_in['k_cache'], 'A_v_cache': _A_in['v_cache'], 'A_wq': _A_in['wq'], 'A_wo': _A_in['wo'], 'B_x': _B_in['x'], 'B_w_gate': _B_in['w_gate'], 'B_w_up': _B_in['w_up'], 'B_w_down': _B_in['w_down'], 'c': _w((lambda *s: torch.randn(*s, dtype=torch.bfloat16) * 0.1)(2, 448) * 8.0), 'w_mod': _w((lambda *s: torch.randn(*s, dtype=torch.bfloat16) * 0.1)(448, 6 * 448) * 448 ** (-0.5) * 8.0)}

def reference(A_x, A_k_cache, A_v_cache, A_wq, A_wo, B_x, B_w_gate, B_w_up, B_w_down, c, w_mod):

    def _A_ref(x, k_cache, v_cache, wq, wo):
        B, Sq, D = x.shape
        Hq, Dh = (16, 256)
        Hkv, Sk = (k_cache.shape[1], k_cache.shape[2])
        W = min(4096, max(256, Sk // 4))
        rep = Hq // Hkv
        q = (lambda x, *d: x.permute(*d))((x @ wq).reshape(B, Sq, Hq, Dh), 0, 2, 1, 3)
        k = (lambda x, n, axis: torch.repeat_interleave(x, n, dim=axis))(k_cache[:, :, Sk - W:, :], rep, axis=1)
        v = (lambda x, n, axis: torch.repeat_interleave(x, n, dim=axis))(v_cache[:, :, Sk - W:, :], rep, axis=1)
        scores = torch.einsum('bhqd,bhkd->bhqk', q, k) * Dh ** (-0.5)
        p = _softmax(scores, axis=-1)
        o = torch.einsum('bhqk,bhkd->bhqd', p, v)
        return (lambda x, *d: x.permute(*d))(o, 0, 2, 1, 3).reshape(B, Sq, Hq * Dh) @ wo

    def _B_ref(x, w_gate, w_up, w_down):
        g = _silu(x @ w_gate)
        u = x @ w_up
        return g * u @ w_down
    x = A_x
    mod = (_silu(c) @ w_mod).reshape(c.shape[0], 6, 1, -1)
    sa, ca, ga, sb, cb, gb = (mod[:, 0].clone(), mod[:, 1].clone(), mod[:, 2].clone(), mod[:, 3].clone(), mod[:, 4].clone(), mod[:, 5].clone())
    h = _layernorm(x, axis=-1) * (1 + ca) + sa
    x = x + ga * _A_ref(h, A_k_cache, A_v_cache, A_wq, A_wo)
    h = _layernorm(x, axis=-1) * (1 + cb) + sb
    x = x + gb * _B_ref(h, B_w_gate, B_w_up, B_w_down)
    return x
```

```asm
; @launch grid=(256,1,1) block=(512,1,1) lds=151552
.amdgcn_target "amdgcn-amd-amdhsa--gfx950"
.text
.globl adaLN_cond__sliding_block_cached__swiglu_ffn__decode_kernel
.p2align 8
.type adaLN_cond__sliding_block_cached__swiglu_ffn__decode_kernel,@function
adaLN_cond__sliding_block_cached__swiglu_ffn__decode_kernel:
    s_cmp_ge_u32 s2, 256
    s_cbranch_scc1 L_exit
    s_load_dwordx16 s[4:19], s[0:1], 0
    s_load_dwordx8 s[20:27], s[0:1], 64
    s_load_dwordx2 s[28:29], s[0:1], 104
    v_lshrrev_b32 v1, 6, v0
    s_getpc_b64 s[98:99]
L_pc:
    v_readfirstlane_b32 s30, v1
    s_lshr_b32 s60, s2, 3
    s_lshl_b32 s60, s60, 10
    v_lshl_add_u32 v1, v0, 1, s60
    v_min_u32 v1, L_exit-L_pc, v1
    global_load_ushort v255, v1, s[98:99]
    v_and_b32 v0, 63, v0
    s_lshr_b32 s33, s2, 3
    s_and_b32 s31, s30, 3
    v_lshrrev_b32 v250, 3, v0
    v_and_b32 v251, 6, v250
    v_xor_b32 v251, v251, v0
    v_and_b32 v251, 7, v251
    v_lshlrev_b32 v251, 4, v251
    s_sub_u32 s60, s2, 1
    s_and_b32 s60, s60, 7
    s_cmp_eq_u32 s60, 7
    s_cbranch_scc1 L_tailxcd
    s_and_b32 s32, s33, 15
    s_lshr_b32 s34, s33, 4
    s_lshl1_add_u32 s34, s60, s34
    s_lshl_b32 s34, s34, 2
    s_mov_b32 s62, 0x321010
    s_mov_b32 s63, 0x321010
    s_lshr_b64 s[62:63], s[62:63], s34
    s_mov_b32 s64, 0x10331133
    s_mov_b32 s65, 0x331033
    s_lshr_b64 s[64:65], s[64:65], s34
    s_mov_b32 s88, 0xac008800
    s_mov_b32 s89, 0x44ad44
    s_lshr_b64 s[88:89], s[88:89], s34
    s_add_u32 s62, s62, s32
    s_and_b32 s62, s62, s64
    s_add_u32 s34, s62, s88
    s_and_b32 s34, s34, 15
    s_bfm_b32 s35, s34, 0
    s_cmp_lt_u32 s30, 4
    s_cbranch_scc1 L_kwave
    s_bitcmp1_b32 0x3000, s34
    s_cbranch_scc1 L_ejob
    s_bitcmp1_b32 0x511, s34
    s_cbranch_scc1 L_qjob
    s_bitcmp1_b32 0x40, s34
    s_cbranch_scc1 L_mjob0
    s_branch L_vnoe
L_kwave:
    v_lshrrev_b32 v4, 4, v0
    v_and_b32 v5, 3, v0
    v_bfe_u32 v6, v0, 2, 2
    v_lshlrev_b32 v1, 9, v6
    v_lshl_add_u32 v1, v4, 6, v1
    v_lshl_add_u32 v1, v5, 4, v1
    s_lshl_b32 s60, s32, 24
    s_lshl_b32 s61, s31, 11
    s_add_u32 s60, s60, s61
    s_and_b32 s61, s32, 3
    s_lshl_b32 s61, s61, 13
    s_add_u32 s60, s60, s61
    s_add_u32 s60, s60, 14680064
    s_lshl_b32 s64, s34, 13
    s_mov_b32 s42, 0x10000000
    s_mov_b32 s43, 0x20000
    s_bitcmp1_b32 0x3551, s34
    s_cbranch_scc1 L_kjob
    s_waitcnt lgkmcnt(0)
L_kgo:
    s_mov_b32 s40, s6
    s_mov_b32 s41, s7
    s_bitcmp1_b32 0xaae, s34
    s_cbranch_scc0 L_abs_1
    s_and_b32 s62, s35, 0xaae
    s_bcnt1_i32_b32 s62, s62
    s_add_u32 s62, s62, 0
    s_lshl_b32 s62, s62, 13
    s_xor_b32 s62, s62, s60
    buffer_load_dwordx4 v[72:75], v1, s[40:43], s62 offen offset:0 nt
    buffer_load_dwordx4 v[76:79], v1, s[40:43], s62 offen offset:256 nt
L_abs_1:
    s_bitcmp1_b32 0xaae, s34
    s_cbranch_scc0 L_abs_2
    s_and_b32 s62, s35, 0xaae
    s_bcnt1_i32_b32 s62, s62
    s_add_u32 s62, s62, 7
    s_lshl_b32 s62, s62, 13
    s_xor_b32 s62, s62, s60
    buffer_load_dwordx4 v[80:83], v1, s[40:43], s62 offen offset:0 nt
    buffer_load_dwordx4 v[84:87], v1, s[40:43], s62 offen offset:256 nt
L_abs_2:
    s_xor_b32 s60, s60, 0x2000
    s_bitcmp1_b32 0xaae, s34
    s_cbranch_scc0 L_abs_3
    s_and_b32 s62, s35, 0xaae
    s_bcnt1_i32_b32 s62, s62
    s_add_u32 s62, s62, 14
    s_lshl_b32 s62, s62, 13
    s_xor_b32 s62, s62, s60
    buffer_load_dwordx4 v[88:91], v1, s[40:43], s62 offen offset:0 nt
    buffer_load_dwordx4 v[92:95], v1, s[40:43], s62 offen offset:256 nt
L_abs_3:
    s_bitcmp1_b32 0x3551, s34
    s_cbranch_scc1 L_kset
    s_mov_b32 s39, 1000000
    s_mov_b32 s66, -1
    s_mov_b32 s67, 0x00ffffff
    v_mov_b32 v7, 0x40000000
    s_waitcnt lgkmcnt(0)
    s_mov_b32 s44, s28
    s_mov_b32 s45, s29
    s_mov_b32 s46, 0x100000
    s_mov_b32 s47, 0x20000
    s_lshl_b32 s61, s31, 9
    s_add_u32 s61, s61, 139584
    v_lshl_add_u32 v3, v0, 3, s61
    v_mov_b32 v8, 0
    v_mov_b32 v9, 0
    ds_write_b64 v3, v[8:9]
    v_mov_b32 v11, 138496
    ds_write_b32 v11, v8
    s_cmp_eq_u32 s34, 10
    s_cselect_b32 s88, 10, 10
    s_bitcmp1_b32 0x511, s34
    s_cselect_b32 s88, s88, 5
    s_cselect_b32 s89, 2, 0
    s_bitcmp1_b32 0x40, s34
    s_cselect_b32 s88, 9, s88
    s_cselect_b32 s89, 1, s89
    s_bitcmp1_b32 0x3000, s34
    s_cselect_b32 s88, 6, s88
    s_cselect_b32 s89, 1, s89
    v_mov_b64 v[12:13], -1
    v_mov_b64 v[14:15], -1
    v_lshlrev_b32 v2, 4, v0
    v_cmp_gt_u32 vcc, 16, v0
    s_nop 1
    v_cndmask_b32 v2, v7, v2, vcc
    s_and_b32 s62, s32, 7
    s_lshl_b32 s62, s62, 15
    s_lshr_b32 s63, s32, 3
    s_lshl_b32 s63, s63, 14
    s_add_u32 s62, s62, s63
    s_lshl_b32 s63, s34, 10
    s_add_u32 s62, s62, s63
    s_lshl_b32 s63, s31, 8
    s_add_u32 s62, s62, s63
    s_add_u32 s62, s62, 131072
    buffer_store_dwordx4 v[12:15], v2, s[44:47], s62 offen sc1
    s_waitcnt lgkmcnt(0)
    s_load_dword s38, s[28:29], 0
L_kset:
    s_mov_b32 s44, s28
    s_mov_b32 s45, s29
    s_mov_b32 s46, 0x100000
    s_mov_b32 s47, 0x20000
    s_bitcmp1_b32 0x3aae, s34
    s_cbranch_scc0 L_abs_4
    s_and_b32 s62, s35, 0x3aae
    s_bcnt1_i32_b32 s62, s62
    s_add_u32 s62, s62, 21
    s_lshl_b32 s62, s62, 13
    s_xor_b32 s62, s62, s60
    buffer_load_dwordx4 v[96:99], v1, s[40:43], s62 offen offset:0 nt
    buffer_load_dwordx4 v[100:103], v1, s[40:43], s62 offen offset:256 nt
L_abs_4:
    s_xor_b32 s60, s60, 0x2000
    s_bitcmp1_b32 0x3aae, s34
    s_cbranch_scc0 L_abs_5
    s_and_b32 s62, s35, 0x3aae
    s_bcnt1_i32_b32 s62, s62
    s_add_u32 s62, s62, 30
    s_lshl_b32 s62, s62, 13
    s_xor_b32 s62, s62, s60
    buffer_load_dwordx4 v[104:107], v1, s[40:43], s62 offen offset:0 nt
    buffer_load_dwordx4 v[108:111], v1, s[40:43], s62 offen offset:256 nt
L_abs_5:
    s_cmp_eq_u32 s88, 5
    s_cbranch_scc0 L_kh_6
    s_barrier
    s_cmp_eq_u32 s89, 0
    s_cbranch_scc1 L_kh_6
    s_barrier
    s_cmp_eq_u32 s89, 1
    s_cbranch_scc1 L_kh_6
    s_barrier
L_kh_6:
    s_bitcmp1_b32 0x3aae, s34
    s_cbranch_scc0 L_abs_7
    s_and_b32 s62, s35, 0x3aae
    s_bcnt1_i32_b32 s62, s62
    s_add_u32 s62, s62, 39
    s_lshl_b32 s62, s62, 13
    s_xor_b32 s62, s62, s60
    buffer_load_dwordx4 v[112:115], v1, s[40:43], s62 offen offset:0 nt
    buffer_load_dwordx4 v[116:119], v1, s[40:43], s62 offen offset:256 nt
L_abs_7:
    s_cmp_eq_u32 s88, 6
    s_cbranch_scc0 L_kh_8
    s_barrier
    s_cmp_eq_u32 s89, 0
    s_cbranch_scc1 L_kh_8
    s_barrier
    s_cmp_eq_u32 s89, 1
    s_cbranch_scc1 L_kh_8
    s_barrier
L_kh_8:
    s_xor_b32 s60, s60, 0x2000
    s_bitcmp1_b32 0x3aee, s34
    s_cbranch_scc0 L_abs_9
    s_and_b32 s62, s35, 0x3aee
    s_bcnt1_i32_b32 s62, s62
    s_add_u32 s62, s62, 48
    s_lshl_b32 s62, s62, 13
    s_xor_b32 s62, s62, s60
    buffer_load_dwordx4 v[120:123], v1, s[40:43], s62 offen offset:0 nt
    buffer_load_dwordx4 v[124:127], v1, s[40:43], s62 offen offset:256 nt
L_abs_9:
    s_bitcmp1_b32 0x3aee, s34
    s_cbranch_scc0 L_abs_10
    s_and_b32 s62, s35, 0x3aee
    s_bcnt1_i32_b32 s62, s62
    s_add_u32 s62, s62, 58
    s_lshl_b32 s62, s62, 13
    s_xor_b32 s62, s62, s60
    buffer_load_dwordx4 v[128:131], v1, s[40:43], s62 offen offset:0 nt
    buffer_load_dwordx4 v[132:135], v1, s[40:43], s62 offen offset:256 nt
L_abs_10:
    s_xor_b32 s60, s60, 0x2000
    s_bitcmp1_b32 0x3aee, s34
    s_cbranch_scc0 L_abs_11
    s_and_b32 s62, s35, 0x3aee
    s_bcnt1_i32_b32 s62, s62
    s_add_u32 s62, s62, 68
    s_lshl_b32 s62, s62, 13
    s_xor_b32 s62, s62, s60
    buffer_load_dwordx4 v[136:139], v1, s[40:43], s62 offen offset:0 nt
    buffer_load_dwordx4 v[140:143], v1, s[40:43], s62 offen offset:256 nt
L_abs_11:
    s_cmp_eq_u32 s88, 9
    s_cbranch_scc0 L_kh_12
    s_barrier
    s_cmp_eq_u32 s89, 0
    s_cbranch_scc1 L_kh_12
    s_barrier
    s_cmp_eq_u32 s89, 1
    s_cbranch_scc1 L_kh_12
    s_barrier
L_kh_12:
    s_bitcmp1_b32 0x3aee, s34
    s_cbranch_scc0 L_abs_13
    s_and_b32 s62, s35, 0x3aee
    s_bcnt1_i32_b32 s62, s62
    s_add_u32 s62, s62, 78
    s_lshl_b32 s62, s62, 13
    s_xor_b32 s62, s62, s60
    buffer_load_dwordx4 v[144:147], v1, s[40:43], s62 offen offset:0 nt
    buffer_load_dwordx4 v[148:151], v1, s[40:43], s62 offen offset:256 nt
L_abs_13:
    s_cmp_eq_u32 s88, 10
    s_cbranch_scc0 L_kh_14
    s_barrier
    s_cmp_eq_u32 s89, 0
    s_cbranch_scc1 L_kh_14
    s_barrier
    s_cmp_eq_u32 s89, 1
    s_cbranch_scc1 L_kh_14
    s_barrier
L_kh_14:
    s_xor_b32 s60, s60, 0x2000
    s_add_u32 s62, s64, 0xb0000
    s_xor_b32 s62, s62, s60
    buffer_load_dwordx4 v[152:155], v1, s[40:43], s62 offen offset:0 nt
    buffer_load_dwordx4 v[156:159], v1, s[40:43], s62 offen offset:256 nt
    s_add_u32 s62, s64, 0xcc000
    s_xor_b32 s62, s62, s60
    buffer_load_dwordx4 v[160:163], v1, s[40:43], s62 offen offset:0 nt
    buffer_load_dwordx4 v[164:167], v1, s[40:43], s62 offen offset:256 nt
    s_xor_b32 s60, s60, 0x2000
    s_add_u32 s62, s64, 0xe8000
    s_xor_b32 s62, s62, s60
    buffer_load_dwordx4 v[168:171], v1, s[40:43], s62 offen offset:0 nt
    buffer_load_dwordx4 v[172:175], v1, s[40:43], s62 offen offset:256 nt
    s_add_u32 s62, s64, 0x104000
    s_xor_b32 s62, s62, s60
    buffer_load_dwordx4 v[176:179], v1, s[40:43], s62 offen offset:0 nt
    buffer_load_dwordx4 v[180:183], v1, s[40:43], s62 offen offset:256 nt
    s_xor_b32 s60, s60, 0x2000
    s_add_u32 s62, s64, 0x120000
    s_xor_b32 s62, s62, s60
    buffer_load_dwordx4 v[184:187], v1, s[40:43], s62 offen offset:0 nt
    buffer_load_dwordx4 v[188:191], v1, s[40:43], s62 offen offset:256 nt
    s_add_u32 s62, s64, 0x13c000
    s_xor_b32 s62, s62, s60
    buffer_load_dwordx4 v[192:195], v1, s[40:43], s62 offen offset:0 nt
    buffer_load_dwordx4 v[196:199], v1, s[40:43], s62 offen offset:256 nt
    s_xor_b32 s60, s60, 0x2000
    s_add_u32 s62, s64, 0x158000
    s_xor_b32 s62, s62, s60
    buffer_load_dwordx4 v[200:203], v1, s[40:43], s62 offen offset:0 nt
    buffer_load_dwordx4 v[204:207], v1, s[40:43], s62 offen offset:256 nt
    s_add_u32 s62, s64, 0x174000
    s_xor_b32 s62, s62, s60
    buffer_load_dwordx4 v[208:211], v1, s[40:43], s62 offen offset:0 nt
    buffer_load_dwordx4 v[212:215], v1, s[40:43], s62 offen offset:256 nt
    s_xor_b32 s60, s60, 0x2000
    s_add_u32 s62, s64, 0x190000
    s_xor_b32 s62, s62, s60
    buffer_load_dwordx4 v[216:219], v1, s[40:43], s62 offen offset:0 nt
    buffer_load_dwordx4 v[220:223], v1, s[40:43], s62 offen offset:256 nt
    s_and_b32 s65, s32, 7
    s_lshl2_add_u32 s65, s65, s31
    s_lshl_b32 s65, s65, 10
    s_add_u32 s65, s65, 32768
    v_lshlrev_b32 v10, 4, v0
    s_bitcmp1_b32 0x551, s34
    s_cbranch_scc0 L_noq0
    buffer_load_dwordx4 v[16:19], v10, s[44:47], s65 offen sc1
L_noq0:
    s_add_u32 s62, s64, 0x1ac000
    s_xor_b32 s62, s62, s60
    buffer_load_dwordx4 v[224:227], v1, s[40:43], s62 offen offset:0 nt
    buffer_load_dwordx4 v[228:231], v1, s[40:43], s62 offen offset:256 nt
    s_xor_b32 s60, s60, 0x2000
    s_add_u32 s62, s64, 0x1c8000
    s_xor_b32 s62, s62, s60
    buffer_load_dwordx4 v[232:235], v1, s[40:43], s62 offen offset:0 nt
    buffer_load_dwordx4 v[236:239], v1, s[40:43], s62 offen offset:256 nt
    s_add_u32 s62, s64, 0x1e4000
    s_xor_b32 s62, s62, s60
    buffer_load_dwordx4 v[240:243], v1, s[40:43], s62 offen offset:0 nt
    buffer_load_dwordx4 v[244:247], v1, s[40:43], s62 offen offset:256 nt
    v_bfe_u32 v6, v0, 3, 1
    v_lshlrev_b32 v2, 10, v6
    v_lshl_add_u32 v2, v4, 7, v2
    v_lshl_add_u32 v2, v5, 5, v2
    v_add_u32 v2, 139584, v2
    s_lshl_b32 s64, s32, 11
    s_waitcnt lgkmcnt(0)
    s_mul_i32 s38, s38, 0x9e3779b1
    s_add_u32 s38, s38, 0x7f4a7c15
    s_cmp_ge_u32 s32, 8
    s_mov_b32 s61, 0x05040100
    s_cselect_b32 s61, 0x07060302, s61
    s_bitcmp1_b32 0x551, s34
    s_cbranch_scc0 L_qlate
    s_waitcnt vmcnt(6)
    v_cmp_ne_u32 vcc, s38, v17
    v_cmp_ne_u32 s[68:69], s38, v19
    v_perm_b32 v8, v18, v16, s61
    s_or_b64 vcc, vcc, s[68:69]
    s_cbranch_scc0 L_qgot_15
L_qlate:
    s_waitcnt vmcnt(2)
L_q_16:
    s_sub_u32 s39, s39, 1
    s_cbranch_scc1 L_end
    buffer_load_dwordx4 v[16:19], v10, s[44:47], s65 offen sc1
    s_waitcnt vmcnt(0)
    v_cmp_ne_u32 vcc, s38, v17
    v_cmp_ne_u32 s[68:69], s38, v19
    v_perm_b32 v8, v18, v16, s61
    s_or_b64 vcc, vcc, s[68:69]
    s_cbranch_scc1 L_q_16
L_qgot_15:
    v_mov_b32 v9, 1
    ds_write_b64 v3, v[8:9]
L_ql_17:
    s_sub_u32 s39, s39, 1
    s_cbranch_scc1 L_end
    ds_read_b128 v[32:35], v2 offset:0
    ds_read_b128 v[36:39], v2 offset:16
    ds_read_b128 v[40:43], v2 offset:512
    ds_read_b128 v[44:47], v2 offset:528
    s_waitcnt lgkmcnt(0)
    v_min3_u32 v8, v33, v35, v37
    v_min3_u32 v9, v39, v41, v43
    v_min3_u32 v8, v8, v45, v47
    v_min_u32 v8, v8, v9
    v_cmp_eq_u32 vcc, 0, v8
    s_cbranch_vccnz L_ql_17
    v_mov_b32 v8, v32
    v_mov_b32 v9, v34
    v_mov_b32 v10, v36
    v_mov_b32 v11, v38
    v_mov_b32 v12, v40
    v_mov_b32 v13, v42
    v_mov_b32 v14, v44
    v_mov_b32 v15, v46
    v_mov_b32 v2, 0xff800000
    v_mov_b32 v48, v2
    v_mov_b32 v49, v2
    v_mov_b32 v50, v2
    v_mov_b32 v51, v2
    v_mov_b32 v52, v2
    v_mov_b32 v53, v2
    v_mov_b32 v54, v2
    v_mov_b32 v55, v2
    s_bitcmp1_b32 0x511, s34
    s_cbranch_scc1 L_qkskip
    v_mfma_f32_16x16x32_bf16 v[32:35], v[72:75], v[8:11], 0
    v_mfma_f32_16x16x32_bf16 v[32:35], v[76:79], v[12:15], v[32:35]
    v_mfma_f32_16x16x32_bf16 v[36:39], v[80:83], v[8:11], 0
    v_mfma_f32_16x16x32_bf16 v[36:39], v[84:87], v[12:15], v[36:39]
    v_mfma_f32_16x16x32_bf16 v[40:43], v[88:91], v[8:11], 0
    v_mfma_f32_16x16x32_bf16 v[40:43], v[92:95], v[12:15], v[40:43]
    s_nop 3
    v_mov_b32_dpp v48, v32 quad_perm:[0,0,0,0] row_mask:0xf bank_mask:0xf
    v_add_f32_dpp v48, v33, v48 quad_perm:[1,1,1,1] row_mask:0xf bank_mask:0xf
    v_add_f32_dpp v48, v34, v48 quad_perm:[2,2,2,2] row_mask:0xf bank_mask:0xf
    v_add_f32_dpp v48, v35, v48 quad_perm:[3,3,3,3] row_mask:0xf bank_mask:0xf
    s_bitcmp1_b32 0xaae, s34
    s_cselect_b64 vcc, -1, 0
    v_cndmask_b32 v48, v2, v48, vcc
    v_mfma_f32_16x16x32_bf16 v[44:47], v[96:99], v[8:11], 0
    v_mfma_f32_16x16x32_bf16 v[44:47], v[100:103], v[12:15], v[44:47]
    v_mov_b32_dpp v49, v36 quad_perm:[0,0,0,0] row_mask:0xf bank_mask:0xf
    v_add_f32_dpp v49, v37, v49 quad_perm:[1,1,1,1] row_mask:0xf bank_mask:0xf
    v_add_f32_dpp v49, v38, v49 quad_perm:[2,2,2,2] row_mask:0xf bank_mask:0xf
    v_add_f32_dpp v49, v39, v49 quad_perm:[3,3,3,3] row_mask:0xf bank_mask:0xf
    s_bitcmp1_b32 0xaae, s34
    s_cselect_b64 vcc, -1, 0
    v_cndmask_b32 v49, v2, v49, vcc
    v_mfma_f32_16x16x32_bf16 v[32:35], v[104:107], v[8:11], 0
    v_mfma_f32_16x16x32_bf16 v[32:35], v[108:111], v[12:15], v[32:35]
    v_mov_b32_dpp v50, v40 quad_perm:[0,0,0,0] row_mask:0xf bank_mask:0xf
    v_add_f32_dpp v50, v41, v50 quad_perm:[1,1,1,1] row_mask:0xf bank_mask:0xf
    v_add_f32_dpp v50, v42, v50 quad_perm:[2,2,2,2] row_mask:0xf bank_mask:0xf
    v_add_f32_dpp v50, v43, v50 quad_perm:[3,3,3,3] row_mask:0xf bank_mask:0xf
    s_bitcmp1_b32 0xaae, s34
    s_cselect_b64 vcc, -1, 0
    v_cndmask_b32 v50, v2, v50, vcc
    v_mfma_f32_16x16x32_bf16 v[36:39], v[112:115], v[8:11], 0
    v_mfma_f32_16x16x32_bf16 v[36:39], v[116:119], v[12:15], v[36:39]
    v_mov_b32_dpp v51, v44 quad_perm:[0,0,0,0] row_mask:0xf bank_mask:0xf
    v_add_f32_dpp v51, v45, v51 quad_perm:[1,1,1,1] row_mask:0xf bank_mask:0xf
    v_add_f32_dpp v51, v46, v51 quad_perm:[2,2,2,2] row_mask:0xf bank_mask:0xf
    v_add_f32_dpp v51, v47, v51 quad_perm:[3,3,3,3] row_mask:0xf bank_mask:0xf
    s_bitcmp1_b32 0x3aae, s34
    s_cselect_b64 vcc, -1, 0
    v_cndmask_b32 v51, v2, v51, vcc
    v_mfma_f32_16x16x32_bf16 v[40:43], v[120:123], v[8:11], 0
    v_mfma_f32_16x16x32_bf16 v[40:43], v[124:127], v[12:15], v[40:43]
    v_mov_b32_dpp v52, v32 quad_perm:[0,0,0,0] row_mask:0xf bank_mask:0xf
    v_add_f32_dpp v52, v33, v52 quad_perm:[1,1,1,1] row_mask:0xf bank_mask:0xf
    v_add_f32_dpp v52, v34, v52 quad_perm:[2,2,2,2] row_mask:0xf bank_mask:0xf
    v_add_f32_dpp v52, v35, v52 quad_perm:[3,3,3,3] row_mask:0xf bank_mask:0xf
    s_bitcmp1_b32 0x3aae, s34
    s_cselect_b64 vcc, -1, 0
    v_cndmask_b32 v52, v2, v52, vcc
    v_mfma_f32_16x16x32_bf16 v[44:47], v[128:131], v[8:11], 0
    v_mfma_f32_16x16x32_bf16 v[44:47], v[132:135], v[12:15], v[44:47]
    v_mov_b32_dpp v53, v36 quad_perm:[0,0,0,0] row_mask:0xf bank_mask:0xf
    v_add_f32_dpp v53, v37, v53 quad_perm:[1,1,1,1] row_mask:0xf bank_mask:0xf
    v_add_f32_dpp v53, v38, v53 quad_perm:[2,2,2,2] row_mask:0xf bank_mask:0xf
    v_add_f32_dpp v53, v39, v53 quad_perm:[3,3,3,3] row_mask:0xf bank_mask:0xf
    s_bitcmp1_b32 0x3aae, s34
    s_cselect_b64 vcc, -1, 0
    v_cndmask_b32 v53, v2, v53, vcc
    v_mfma_f32_16x16x32_bf16 v[32:35], v[136:139], v[8:11], 0
    v_mfma_f32_16x16x32_bf16 v[32:35], v[140:143], v[12:15], v[32:35]
    v_mov_b32_dpp v54, v40 quad_perm:[0,0,0,0] row_mask:0xf bank_mask:0xf
    v_add_f32_dpp v54, v41, v54 quad_perm:[1,1,1,1] row_mask:0xf bank_mask:0xf
    v_add_f32_dpp v54, v42, v54 quad_perm:[2,2,2,2] row_mask:0xf bank_mask:0xf
    v_add_f32_dpp v54, v43, v54 quad_perm:[3,3,3,3] row_mask:0xf bank_mask:0xf
    s_bitcmp1_b32 0x3aee, s34
    s_cselect_b64 vcc, -1, 0
    v_cndmask_b32 v54, v2, v54, vcc
    v_mfma_f32_16x16x32_bf16 v[36:39], v[144:147], v[8:11], 0
    v_mfma_f32_16x16x32_bf16 v[36:39], v[148:151], v[12:15], v[36:39]
    v_mov_b32_dpp v55, v44 quad_perm:[0,0,0,0] row_mask:0xf bank_mask:0xf
    v_add_f32_dpp v55, v45, v55 quad_perm:[1,1,1,1] row_mask:0xf bank_mask:0xf
    v_add_f32_dpp v55, v46, v55 quad_perm:[2,2,2,2] row_mask:0xf bank_mask:0xf
    v_add_f32_dpp v55, v47, v55 quad_perm:[3,3,3,3] row_mask:0xf bank_mask:0xf
    s_bitcmp1_b32 0x3aee, s34
    s_cselect_b64 vcc, -1, 0
    v_cndmask_b32 v55, v2, v55, vcc
L_qkskip:
    v_mfma_f32_16x16x32_bf16 v[40:43], v[152:155], v[8:11], 0
    v_mfma_f32_16x16x32_bf16 v[40:43], v[156:159], v[12:15], v[40:43]
    v_mov_b32_dpp v56, v32 quad_perm:[0,0,0,0] row_mask:0xf bank_mask:0xf
    v_add_f32_dpp v56, v33, v56 quad_perm:[1,1,1,1] row_mask:0xf bank_mask:0xf
    v_add_f32_dpp v56, v34, v56 quad_perm:[2,2,2,2] row_mask:0xf bank_mask:0xf
    v_add_f32_dpp v56, v35, v56 quad_perm:[3,3,3,3] row_mask:0xf bank_mask:0xf
    s_bitcmp1_b32 0x3aee, s34
    s_cselect_b64 vcc, -1, 0
    v_cndmask_b32 v56, v2, v56, vcc
    v_mfma_f32_16x16x32_bf16 v[44:47], v[160:163], v[8:11], 0
    v_mfma_f32_16x16x32_bf16 v[44:47], v[164:167], v[12:15], v[44:47]
    v_mov_b32_dpp v57, v36 quad_perm:[0,0,0,0] row_mask:0xf bank_mask:0xf
    v_add_f32_dpp v57, v37, v57 quad_perm:[1,1,1,1] row_mask:0xf bank_mask:0xf
    v_add_f32_dpp v57, v38, v57 quad_perm:[2,2,2,2] row_mask:0xf bank_mask:0xf
    v_add_f32_dpp v57, v39, v57 quad_perm:[3,3,3,3] row_mask:0xf bank_mask:0xf
    s_bitcmp1_b32 0x3aee, s34
    s_cselect_b64 vcc, -1, 0
    v_cndmask_b32 v57, v2, v57, vcc
    v_mfma_f32_16x16x32_bf16 v[32:35], v[168:171], v[8:11], 0
    v_mfma_f32_16x16x32_bf16 v[32:35], v[172:175], v[12:15], v[32:35]
    v_mov_b32_dpp v58, v40 quad_perm:[0,0,0,0] row_mask:0xf bank_mask:0xf
    v_add_f32_dpp v58, v41, v58 quad_perm:[1,1,1,1] row_mask:0xf bank_mask:0xf
    v_add_f32_dpp v58, v42, v58 quad_perm:[2,2,2,2] row_mask:0xf bank_mask:0xf
    v_add_f32_dpp v58, v43, v58 quad_perm:[3,3,3,3] row_mask:0xf bank_mask:0xf
    v_mfma_f32_16x16x32_bf16 v[36:39], v[176:179], v[8:11], 0
    v_mfma_f32_16x16x32_bf16 v[36:39], v[180:183], v[12:15], v[36:39]
    v_mov_b32_dpp v59, v44 quad_perm:[0,0,0,0] row_mask:0xf bank_mask:0xf
    v_add_f32_dpp v59, v45, v59 quad_perm:[1,1,1,1] row_mask:0xf bank_mask:0xf
    v_add_f32_dpp v59, v46, v59 quad_perm:[2,2,2,2] row_mask:0xf bank_mask:0xf
    v_add_f32_dpp v59, v47, v59 quad_perm:[3,3,3,3] row_mask:0xf bank_mask:0xf
    v_mfma_f32_16x16x32_bf16 v[40:43], v[184:187], v[8:11], 0
    v_mfma_f32_16x16x32_bf16 v[40:43], v[188:191], v[12:15], v[40:43]
    v_mov_b32_dpp v60, v32 quad_perm:[0,0,0,0] row_mask:0xf bank_mask:0xf
    v_add_f32_dpp v60, v33, v60 quad_perm:[1,1,1,1] row_mask:0xf bank_mask:0xf
    v_add_f32_dpp v60, v34, v60 quad_perm:[2,2,2,2] row_mask:0xf bank_mask:0xf
    v_add_f32_dpp v60, v35, v60 quad_perm:[3,3,3,3] row_mask:0xf bank_mask:0xf
    v_mfma_f32_16x16x32_bf16 v[44:47], v[192:195], v[8:11], 0
    v_mfma_f32_16x16x32_bf16 v[44:47], v[196:199], v[12:15], v[44:47]
    v_mov_b32_dpp v61, v36 quad_perm:[0,0,0,0] row_mask:0xf bank_mask:0xf
    v_add_f32_dpp v61, v37, v61 quad_perm:[1,1,1,1] row_mask:0xf bank_mask:0xf
    v_add_f32_dpp v61, v38, v61 quad_perm:[2,2,2,2] row_mask:0xf bank_mask:0xf
    v_add_f32_dpp v61, v39, v61 quad_perm:[3,3,3,3] row_mask:0xf bank_mask:0xf
    v_mfma_f32_16x16x32_bf16 v[32:35], v[200:203], v[8:11], 0
    v_mfma_f32_16x16x32_bf16 v[32:35], v[204:207], v[12:15], v[32:35]
    v_mov_b32_dpp v62, v40 quad_perm:[0,0,0,0] row_mask:0xf bank_mask:0xf
    v_add_f32_dpp v62, v41, v62 quad_perm:[1,1,1,1] row_mask:0xf bank_mask:0xf
    v_add_f32_dpp v62, v42, v62 quad_perm:[2,2,2,2] row_mask:0xf bank_mask:0xf
    v_add_f32_dpp v62, v43, v62 quad_perm:[3,3,3,3] row_mask:0xf bank_mask:0xf
    v_mfma_f32_16x16x32_bf16 v[36:39], v[208:211], v[8:11], 0
    v_mfma_f32_16x16x32_bf16 v[36:39], v[212:215], v[12:15], v[36:39]
    v_mov_b32_dpp v63, v44 quad_perm:[0,0,0,0] row_mask:0xf bank_mask:0xf
    v_add_f32_dpp v63, v45, v63 quad_perm:[1,1,1,1] row_mask:0xf bank_mask:0xf
    v_add_f32_dpp v63, v46, v63 quad_perm:[2,2,2,2] row_mask:0xf bank_mask:0xf
    v_add_f32_dpp v63, v47, v63 quad_perm:[3,3,3,3] row_mask:0xf bank_mask:0xf
    v_mfma_f32_16x16x32_bf16 v[40:43], v[216:219], v[8:11], 0
    v_mfma_f32_16x16x32_bf16 v[40:43], v[220:223], v[12:15], v[40:43]
    v_mov_b32_dpp v64, v32 quad_perm:[0,0,0,0] row_mask:0xf bank_mask:0xf
    v_add_f32_dpp v64, v33, v64 quad_perm:[1,1,1,1] row_mask:0xf bank_mask:0xf
    v_add_f32_dpp v64, v34, v64 quad_perm:[2,2,2,2] row_mask:0xf bank_mask:0xf
    v_add_f32_dpp v64, v35, v64 quad_perm:[3,3,3,3] row_mask:0xf bank_mask:0xf
    s_waitcnt vmcnt(4)
    v_mfma_f32_16x16x32_bf16 v[44:47], v[224:227], v[8:11], 0
    v_mfma_f32_16x16x32_bf16 v[44:47], v[228:231], v[12:15], v[44:47]
    v_mov_b32_dpp v65, v36 quad_perm:[0,0,0,0] row_mask:0xf bank_mask:0xf
    v_add_f32_dpp v65, v37, v65 quad_perm:[1,1,1,1] row_mask:0xf bank_mask:0xf
    v_add_f32_dpp v65, v38, v65 quad_perm:[2,2,2,2] row_mask:0xf bank_mask:0xf
    v_add_f32_dpp v65, v39, v65 quad_perm:[3,3,3,3] row_mask:0xf bank_mask:0xf
    s_waitcnt vmcnt(2)
    v_mfma_f32_16x16x32_bf16 v[32:35], v[232:235], v[8:11], 0
    v_mfma_f32_16x16x32_bf16 v[32:35], v[236:239], v[12:15], v[32:35]
    v_mov_b32_dpp v66, v40 quad_perm:[0,0,0,0] row_mask:0xf bank_mask:0xf
    v_add_f32_dpp v66, v41, v66 quad_perm:[1,1,1,1] row_mask:0xf bank_mask:0xf
    v_add_f32_dpp v66, v42, v66 quad_perm:[2,2,2,2] row_mask:0xf bank_mask:0xf
    v_add_f32_dpp v66, v43, v66 quad_perm:[3,3,3,3] row_mask:0xf bank_mask:0xf
    s_waitcnt vmcnt(0)
    v_mfma_f32_16x16x32_bf16 v[36:39], v[240:243], v[8:11], 0
    v_mfma_f32_16x16x32_bf16 v[36:39], v[244:247], v[12:15], v[36:39]
    v_mov_b32_dpp v67, v44 quad_perm:[0,0,0,0] row_mask:0xf bank_mask:0xf
    v_add_f32_dpp v67, v45, v67 quad_perm:[1,1,1,1] row_mask:0xf bank_mask:0xf
    v_add_f32_dpp v67, v46, v67 quad_perm:[2,2,2,2] row_mask:0xf bank_mask:0xf
    v_add_f32_dpp v67, v47, v67 quad_perm:[3,3,3,3] row_mask:0xf bank_mask:0xf
    v_mov_b32_dpp v68, v32 quad_perm:[0,0,0,0] row_mask:0xf bank_mask:0xf
    v_add_f32_dpp v68, v33, v68 quad_perm:[1,1,1,1] row_mask:0xf bank_mask:0xf
    v_add_f32_dpp v68, v34, v68 quad_perm:[2,2,2,2] row_mask:0xf bank_mask:0xf
    v_add_f32_dpp v68, v35, v68 quad_perm:[3,3,3,3] row_mask:0xf bank_mask:0xf
    v_mov_b32_dpp v69, v36 quad_perm:[0,0,0,0] row_mask:0xf bank_mask:0xf
    v_add_f32_dpp v69, v37, v69 quad_perm:[1,1,1,1] row_mask:0xf bank_mask:0xf
    v_add_f32_dpp v69, v38, v69 quad_perm:[2,2,2,2] row_mask:0xf bank_mask:0xf
    v_add_f32_dpp v69, v39, v69 quad_perm:[3,3,3,3] row_mask:0xf bank_mask:0xf
    v_mov_b32 v70, 0xff800000
    v_mov_b32 v71, 0xff800000
    v_cvt_pk_bf16_f32 v16, v48, v49
    v_lshlrev_b32 v48, 16, v16
    v_and_b32 v49, 0xffff0000, v16
    v_cvt_pk_bf16_f32 v17, v50, v51
    v_lshlrev_b32 v50, 16, v17
    v_and_b32 v51, 0xffff0000, v17
    v_cvt_pk_bf16_f32 v18, v52, v53
    v_lshlrev_b32 v52, 16, v18
    v_and_b32 v53, 0xffff0000, v18
    v_cvt_pk_bf16_f32 v19, v54, v55
    v_lshlrev_b32 v54, 16, v19
    v_and_b32 v55, 0xffff0000, v19
    v_cvt_pk_bf16_f32 v20, v56, v57
    v_lshlrev_b32 v56, 16, v20
    v_and_b32 v57, 0xffff0000, v20
    v_cvt_pk_bf16_f32 v21, v58, v59
    v_lshlrev_b32 v58, 16, v21
    v_and_b32 v59, 0xffff0000, v21
    v_cvt_pk_bf16_f32 v22, v60, v61
    v_lshlrev_b32 v60, 16, v22
    v_and_b32 v61, 0xffff0000, v22
    v_cvt_pk_bf16_f32 v23, v62, v63
    v_lshlrev_b32 v62, 16, v23
    v_and_b32 v63, 0xffff0000, v23
    v_cvt_pk_bf16_f32 v24, v64, v65
    v_lshlrev_b32 v64, 16, v24
    v_and_b32 v65, 0xffff0000, v24
    v_cvt_pk_bf16_f32 v25, v66, v67
    v_lshlrev_b32 v66, 16, v25
    v_and_b32 v67, 0xffff0000, v25
    v_cvt_pk_bf16_f32 v26, v68, v69
    v_lshlrev_b32 v68, 16, v26
    v_and_b32 v69, 0xffff0000, v26
    v_max3_f32 v16, v48, v49, v50
    v_max3_f32 v16, v16, v51, v52
    v_max3_f32 v16, v16, v53, v54
    v_max3_f32 v16, v16, v55, v56
    v_max3_f32 v16, v16, v57, v58
    v_max3_f32 v16, v16, v59, v60
    v_max3_f32 v16, v16, v61, v62
    v_max3_f32 v16, v16, v63, v64
    v_max3_f32 v16, v16, v65, v66
    v_max3_f32 v16, v16, v67, v68
    v_max3_f32 v16, v16, v69, v70
    v_mov_b32 v17, v16
    s_nop 1
    v_permlane16_swap_b32 v16, v17
    v_max_f32 v16, v16, v17
    v_mov_b32 v17, v16
    s_nop 1
    v_permlane32_swap_b32 v16, v17
    v_max_f32 v16, v16, v17
    s_mov_b32 s61, 0x3db8aa3b
    v_sub_f32 v48, v48, v16
    v_sub_f32 v49, v49, v16
    v_sub_f32 v50, v50, v16
    v_sub_f32 v51, v51, v16
    v_sub_f32 v52, v52, v16
    v_sub_f32 v53, v53, v16
    v_sub_f32 v54, v54, v16
    v_sub_f32 v55, v55, v16
    v_sub_f32 v56, v56, v16
    v_sub_f32 v57, v57, v16
    v_sub_f32 v58, v58, v16
    v_sub_f32 v59, v59, v16
    v_sub_f32 v60, v60, v16
    v_sub_f32 v61, v61, v16
    v_sub_f32 v62, v62, v16
    v_sub_f32 v63, v63, v16
    v_sub_f32 v64, v64, v16
    v_sub_f32 v65, v65, v16
    v_sub_f32 v66, v66, v16
    v_sub_f32 v67, v67, v16
    v_sub_f32 v68, v68, v16
    v_sub_f32 v69, v69, v16
    v_mul_f32 v48, s61, v48
    v_mul_f32 v49, s61, v49
    v_mul_f32 v50, s61, v50
    v_mul_f32 v51, s61, v51
    v_mul_f32 v52, s61, v52
    v_mul_f32 v53, s61, v53
    v_mul_f32 v54, s61, v54
    v_mul_f32 v55, s61, v55
    v_mul_f32 v56, s61, v56
    v_mul_f32 v57, s61, v57
    v_mul_f32 v58, s61, v58
    v_mul_f32 v59, s61, v59
    v_mul_f32 v60, s61, v60
    v_mul_f32 v61, s61, v61
    v_mul_f32 v62, s61, v62
    v_mul_f32 v63, s61, v63
    v_mul_f32 v64, s61, v64
    v_mul_f32 v65, s61, v65
    v_mul_f32 v66, s61, v66
    v_mul_f32 v67, s61, v67
    v_mul_f32 v68, s61, v68
    v_mul_f32 v69, s61, v69
    v_exp_f32 v48, v48
    v_exp_f32 v49, v49
    v_exp_f32 v50, v50
    v_exp_f32 v51, v51
    v_exp_f32 v52, v52
    v_exp_f32 v53, v53
    v_exp_f32 v54, v54
    v_exp_f32 v55, v55
    v_exp_f32 v56, v56
    v_exp_f32 v57, v57
    v_exp_f32 v58, v58
    v_exp_f32 v59, v59
    v_exp_f32 v60, v60
    v_exp_f32 v61, v61
    v_exp_f32 v62, v62
    v_exp_f32 v63, v63
    v_exp_f32 v64, v64
    v_exp_f32 v65, v65
    v_exp_f32 v66, v66
    v_exp_f32 v67, v67
    v_exp_f32 v68, v68
    v_exp_f32 v69, v69
    v_lshl_add_u32 v3, v6, 2, v4
    v_mul_u32_u24 v3, 96, v3
    s_mul_i32 s60, s31, 768
    s_add_u32 s60, s60, 135296
    v_add_u32 v3, s60, v3
    ds_write_b128 v3, v[48:51] offset:0
    ds_write_b128 v3, v[52:55] offset:16
    ds_write_b128 v3, v[56:59] offset:32
    ds_write_b128 v3, v[60:63] offset:48
    ds_write_b128 v3, v[64:67] offset:64
    ds_write_b128 v3, v[68:71] offset:80
    s_lshl_b32 s60, s31, 2
    s_add_u32 s60, s60, 138368
    v_lshlrev_b32 v3, 4, v6
    v_add_u32 v3, s60, v3
    ds_write_b32 v3, v16
    v_add_f32 v18, v48, v49
    v_add_f32 v18, v18, v50
    v_add_f32 v18, v18, v51
    v_add_f32 v18, v18, v52
    v_add_f32 v18, v18, v53
    v_add_f32 v18, v18, v54
    v_add_f32 v18, v18, v55
    v_add_f32 v18, v18, v56
    v_add_f32 v18, v18, v57
    v_add_f32 v18, v18, v58
    v_add_f32 v18, v18, v59
    v_add_f32 v18, v18, v60
    v_add_f32 v18, v18, v61
    v_add_f32 v18, v18, v62
    v_add_f32 v18, v18, v63
    v_add_f32 v18, v18, v64
    v_add_f32 v18, v18, v65
    v_add_f32 v18, v18, v66
    v_add_f32 v18, v18, v67
    v_add_f32 v18, v18, v68
    v_add_f32 v18, v18, v69
    v_mov_b32 v17, v18
    s_nop 1
    v_permlane16_swap_b32 v18, v17
    v_add_f32 v18, v18, v17
    v_mov_b32 v17, v18
    s_nop 1
    v_permlane32_swap_b32 v18, v17
    v_add_f32 v18, v18, v17
    s_lshl_b32 s60, s31, 3
    s_add_u32 s60, s60, 138432
    v_lshl_add_u32 v3, v6, 5, s60
    v_mov_b32 v17, v18
    ds_write_b64 v3, v[16:17]
    v_mov_b32 v3, 138496
    v_mov_b32 v8, 1
    s_mov_b64 exec, 1
    ds_add_rtn_u32 v8, v3, v8
    s_mov_b64 exec, -1
    v_and_b32 v9, 7, v0
    v_lshlrev_b32 v3, 3, v9
    v_add_u32 v3, 138432, v3
    ds_read_b64 v[20:21], v3
    v_lshlrev_b32 v3, 4, v0
    v_cmp_gt_u32 vcc, 8, v0
    s_nop 1
    v_cndmask_b32 v3, v7, v3, vcc
    s_lshl_b32 s60, s34, 7
    s_add_u32 s60, s60, s64
    s_add_u32 s60, s60, 65536
    s_waitcnt lgkmcnt(0)
    v_readfirstlane_b32 s61, v8
    v_mov_b32 v22, v21
    v_mov_b32 v21, s38
    v_mov_b32 v23, s38
    s_cmp_eq_u32 s61, 3
    s_cbranch_scc0 L_ml_18
    buffer_store_dwordx4 v[20:23], v3, s[44:47], s60 offen sc1
L_ml_18:
    s_waitcnt lgkmcnt(0)
    s_barrier
    s_lshl2_add_u32 s60, s33, s31
    s_lshl_b32 s60, s60, 8
    v_lshl_add_u32 v3, v0, 7, s60
    v_min_u32 v3, L_exit-L_pc, v3
    s_mov_b64 exec, 3
    global_load_dword v1, v3, s[98:99]
    s_mov_b64 exec, -1
    s_branch L_end
L_kjob:
    s_mov_b32 s39, 1000000
    s_mov_b32 s66, -1
    s_mov_b32 s67, 0x00ffffff
    v_mov_b32 v7, 0x40000000
    s_waitcnt lgkmcnt(0)
    s_mov_b32 s44, s28
    s_mov_b32 s45, s29
    s_mov_b32 s46, 0x100000
    s_mov_b32 s47, 0x20000
    s_lshl_b32 s61, s31, 9
    s_add_u32 s61, s61, 139584
    v_lshl_add_u32 v3, v0, 3, s61
    v_mov_b32 v8, 0
    v_mov_b32 v9, 0
    ds_write_b64 v3, v[8:9]
    v_mov_b32 v11, 138496
    ds_write_b32 v11, v8
    s_cmp_eq_u32 s34, 10
    s_cselect_b32 s88, 10, 10
    s_bitcmp1_b32 0x511, s34
    s_cselect_b32 s88, s88, 5
    s_cselect_b32 s89, 2, 0
    s_bitcmp1_b32 0x40, s34
    s_cselect_b32 s88, 9, s88
    s_cselect_b32 s89, 1, s89
    s_bitcmp1_b32 0x3000, s34
    s_cselect_b32 s88, 6, s88
    s_cselect_b32 s89, 1, s89
    v_mov_b64 v[12:13], -1
    v_mov_b64 v[14:15], -1
    v_lshlrev_b32 v2, 4, v0
    v_cmp_gt_u32 vcc, 16, v0
    s_nop 1
    v_cndmask_b32 v2, v7, v2, vcc
    s_and_b32 s62, s32, 7
    s_lshl_b32 s62, s62, 15
    s_lshr_b32 s63, s32, 3
    s_lshl_b32 s63, s63, 14
    s_add_u32 s62, s62, s63
    s_lshl_b32 s63, s34, 10
    s_add_u32 s62, s62, s63
    s_lshl_b32 s63, s31, 8
    s_add_u32 s62, s62, s63
    s_add_u32 s62, s62, 131072
    buffer_store_dwordx4 v[12:15], v2, s[44:47], s62 offen sc1
    s_waitcnt lgkmcnt(0)
    s_load_dword s38, s[28:29], 0
    s_barrier
    s_branch L_kgo
L_ejob:
    v_mul_u32_u24 v9, 5376, v250
    v_add_u32 v9, v9, v251
    s_and_b32 s89, s35, 0x3000
    s_bcnt1_i32_b32 s89, s89
    s_mul_i32 s60, s89, 1204224
    s_lshl_b32 s61, s32, 7
    s_add_u32 s60, s60, s61
    s_cmp_ge_u32 s32, 14
    s_cselect_b32 s60, 0x40000000, s60
    s_mul_i32 s61, s31, 301056
    s_add_u32 s60, s60, s61
    s_mul_i32 s61, s31, 7168
    s_waitcnt lgkmcnt(0)
    s_mov_b32 s48, s24
    s_mov_b32 s49, s25
    s_mov_b32 s50, 0x24c000
    s_mov_b32 s51, 0x20000
    s_mov_b32 m0, s61
    s_add_u32 s61, s61, 1024
    buffer_load_dwordx4 v9, s[48:51], s60 offen nt lds
    s_add_u32 s60, s60, 43008
    s_mov_b32 m0, s61
    s_add_u32 s61, s61, 1024
    buffer_load_dwordx4 v9, s[48:51], s60 offen nt lds
    s_add_u32 s60, s60, 43008
    s_lshl_b32 s62, s31, 6
    v_add_u32 v11, s62, v0
    v_lshlrev_b32 v2, 3, v11
    s_mov_b32 s52, s22
    s_mov_b32 s53, s23
    s_mov_b32 s54, 0x700
    s_mov_b32 s55, 0x20000
    buffer_load_dwordx2 v[16:17], v2, s[52:55], 0 offen
    s_mov_b32 m0, s61
    s_add_u32 s61, s61, 1024
    buffer_load_dwordx4 v9, s[48:51], s60 offen nt lds
    s_add_u32 s60, s60, 43008
    s_mov_b32 m0, s61
    s_add_u32 s61, s61, 1024
    buffer_load_dwordx4 v9, s[48:51], s60 offen nt lds
    s_add_u32 s60, s60, 43008
    s_mov_b32 m0, s61
    s_add_u32 s61, s61, 1024
    buffer_load_dwordx4 v9, s[48:51], s60 offen nt lds
    s_add_u32 s60, s60, 43008
    s_mov_b32 m0, s61
    s_add_u32 s61, s61, 1024
    buffer_load_dwordx4 v9, s[48:51], s60 offen nt lds
    s_add_u32 s60, s60, 43008
    s_mov_b32 m0, s61
    s_nop 0
    buffer_load_dwordx4 v9, s[48:51], s60 offen nt lds
    s_barrier
    s_mov_b32 s39, 1000000
    s_mov_b32 s66, -1
    s_mov_b32 s67, 0x00ffffff
    v_mov_b32 v7, 0x40000000
    s_waitcnt lgkmcnt(0)
    s_load_dword s38, s[28:29], 0
    s_mov_b32 s44, s28
    s_mov_b32 s45, s29
    s_mov_b32 s46, 0x100000
    s_mov_b32 s47, 0x20000
    v_cmp_le_u32 vcc, 112, v11
    v_subrev_u32 v5, 112, v11
    s_nop 0
    v_cndmask_b32 v5, v11, v5, vcc
    v_mov_b32 v10, 131072
    v_mov_b32 v8, 133184
    v_cndmask_b32 v10, v10, v8, vcc
    v_lshrrev_b32 v2, 3, v5
    v_lshlrev_b32 v2, 6, v2
    v_and_b32 v8, 3, v5
    v_lshl_add_u32 v2, v8, 4, v2
    v_bfe_u32 v8, v5, 2, 1
    v_lshl_add_u32 v2, v8, 3, v2
    v_add_u32 v2, v2, v10
    v_mov_b32 v8, 139072
    v_cmp_gt_u32 vcc, 224, v11
    s_nop 1
    v_cndmask_b32 v2, v8, v2, vcc
    s_mov_b32 s62, 0xbfb8aa3b
    s_waitcnt vmcnt(5)
    v_lshlrev_b32 v20, 16, v16
    v_and_b32 v21, 0xffff0000, v16
    v_lshlrev_b32 v22, 16, v17
    v_and_b32 v23, 0xffff0000, v17
    v_mul_f32 v24, s62, v20
    v_mul_f32 v25, s62, v21
    v_mul_f32 v26, s62, v22
    v_mul_f32 v27, s62, v23
    v_exp_f32 v24, v24
    v_exp_f32 v25, v25
    v_exp_f32 v26, v26
    v_exp_f32 v27, v27
    v_add_f32 v24, 1.0, v24
    v_add_f32 v25, 1.0, v25
    v_add_f32 v26, 1.0, v26
    v_add_f32 v27, 1.0, v27
    v_rcp_f32 v24, v24
    v_rcp_f32 v25, v25
    v_rcp_f32 v26, v26
    v_rcp_f32 v27, v27
    v_mul_f32 v20, v20, v24
    v_mul_f32 v21, v21, v25
    v_mul_f32 v22, v22, v26
    v_mul_f32 v23, v23, v27
    v_cvt_pk_bf16_f32 v16, v20, v21
    v_cvt_pk_bf16_f32 v17, v22, v23
    ds_write_b64 v2, v[16:17]
    v_lshrrev_b32 v2, 2, v0
    v_lshlrev_b32 v3, 7, v2
    v_and_b32 v2, 6, v2
    s_lshl_b32 s60, s31, 1
    v_xor_b32 v2, s60, v2
    v_lshlrev_b32 v2, 4, v2
    v_and_b32 v5, 3, v0
    v_lshl_add_u32 v2, v5, 3, v2
    v_add_u32 v3, v3, v2
    v_and_b32 v5, 1, v0
    v_mul_u32_u24 v10, 2112, v5
    v_lshrrev_b32 v5, 4, v0
    v_lshl_add_u32 v10, v5, 4, v10
    v_add_u32 v10, 131072, v10
    s_mul_i32 s60, s89, 448
    v_add_u32 v10, s60, v10
    v_lshlrev_b32 v11, 4, v0
    v_cmp_gt_u32 vcc, 16, v0
    s_nop 1
    v_cndmask_b32 v11, v7, v11, vcc
    s_mul_i32 s62, s89, 14336
    s_lshl_b32 s61, s32, 10
    s_add_u32 s62, s62, s61
    s_lshl_b32 s61, s31, 8
    s_add_u32 s62, s62, s61
    s_add_u32 s62, s62, 589824
    s_cmp_ge_u32 s32, 14
    s_cselect_b32 s62, 0x40000000, s62
    s_waitcnt lgkmcnt(0)
    s_mul_i32 s38, s38, 0x9e3779b1
    s_add_u32 s38, s38, 0x7f4a7c15
    v_mov_b32 v21, s38
    v_mov_b32 v23, s38
    s_waitcnt vmcnt(0)
    s_barrier
    ds_read_b128 v[32:35], v10 offset:0
    ds_read_b64_tr_b16 v[128:129], v3 offset:0
    ds_read_b64_tr_b16 v[130:131], v3 offset:2048
    ds_read_b128 v[36:39], v10 offset:64
    ds_read_b64_tr_b16 v[132:133], v3 offset:4096
    ds_read_b64_tr_b16 v[134:135], v3 offset:6144
    ds_read_b128 v[40:43], v10 offset:128
    ds_read_b64_tr_b16 v[136:137], v3 offset:8192
    ds_read_b64_tr_b16 v[138:139], v3 offset:10240
    ds_read_b128 v[44:47], v10 offset:192
    ds_read_b64_tr_b16 v[140:141], v3 offset:12288
    ds_read_b64_tr_b16 v[142:143], v3 offset:14336
    s_waitcnt lgkmcnt(9)
    v_mfma_f32_16x16x32_bf16 v[16:19], v[32:35], v[128:131], 0
    ds_read_b128 v[48:51], v10 offset:256
    ds_read_b64_tr_b16 v[144:145], v3 offset:16384
    ds_read_b64_tr_b16 v[146:147], v3 offset:18432
    s_waitcnt lgkmcnt(9)
    v_mfma_f32_16x16x32_bf16 v[16:19], v[36:39], v[132:135], v[16:19]
    ds_read_b128 v[52:55], v10 offset:320
    ds_read_b64_tr_b16 v[148:149], v3 offset:20480
    ds_read_b64_tr_b16 v[150:151], v3 offset:22528
    s_waitcnt lgkmcnt(9)
    v_mfma_f32_16x16x32_bf16 v[16:19], v[40:43], v[136:139], v[16:19]
    ds_read_b128 v[56:59], v10 offset:384
    ds_read_b64_tr_b16 v[152:153], v3 offset:24576
    ds_read_b64_tr_b16 v[154:155], v3 offset:26624
    s_waitcnt lgkmcnt(9)
    v_mfma_f32_16x16x32_bf16 v[16:19], v[44:47], v[140:143], v[16:19]
    s_waitcnt lgkmcnt(6)
    v_mfma_f32_16x16x32_bf16 v[16:19], v[48:51], v[144:147], v[16:19]
    s_waitcnt lgkmcnt(3)
    v_mfma_f32_16x16x32_bf16 v[16:19], v[52:55], v[148:151], v[16:19]
    s_waitcnt lgkmcnt(0)
    v_mfma_f32_16x16x32_bf16 v[16:19], v[56:59], v[152:155], v[16:19]
    s_nop 7
    v_mov_b32 v20, v16
    v_mov_b32 v22, v17
    buffer_store_dwordx4 v[20:23], v11, s[44:47], s62 offen sc1
    s_barrier
    s_branch L_vstream
L_vnoe:
    s_mov_b32 s39, 1000000
    s_mov_b32 s66, -1
    s_mov_b32 s67, 0x00ffffff
    v_mov_b32 v7, 0x40000000
    s_waitcnt lgkmcnt(0)
    s_load_dword s38, s[28:29], 0
    s_mov_b32 s44, s28
    s_mov_b32 s45, s29
    s_mov_b32 s46, 0x100000
    s_mov_b32 s47, 0x20000
L_vrel:
    s_barrier
L_vstream:
    s_mov_b32 s40, s8
    s_mov_b32 s41, s9
    s_mov_b32 s42, 0x10000000
    s_mov_b32 s43, 0x20000
    v_lshrrev_b32 v4, 4, v0
    v_bfe_u32 v5, v0, 3, 1
    v_and_b32 v6, 7, v0
    v_lshlrev_b32 v1, 11, v4
    v_lshl_add_u32 v1, v5, 9, v1
    v_lshl_add_u32 v1, v6, 4, v1
    s_lshl_b32 s60, s32, 24
    s_lshl_b32 s61, s31, 7
    s_add_u32 s60, s60, s61
    s_and_b32 s61, s32, 3
    s_lshl_b32 s61, s61, 13
    s_add_u32 s60, s60, s61
    s_add_u32 s60, s60, 14680064
    s_lshl_b32 s64, s34, 13
    v_bfe_u32 v2, v0, 2, 1
    v_mul_u32_u24 v9, 0xffff, v2
    v_xor_b32 v8, 0xffff, v9
    v_lshlrev_b32 v10, 16, v8
    v_lshlrev_b32 v11, 16, v9
    v_and_b32 v3, 2, v4
    v_add_u32 v3, v3, v5
    v_mul_u32_u24 v3, 96, v3
    v_and_b32 v2, 1, v4
    v_mul_u32_u24 v20, 1536, v2
    v_add_u32 v3, v3, v20
    v_add_u32 v3, 135296, v3
    v_lshlrev_b32 v20, 6, v2
    v_lshl_add_u32 v20, v6, 3, v20
    v_lshrrev_b32 v21, 5, v0
    v_lshl_add_u32 v20, v21, 9, v20
    v_cmp_eq_u32 vcc, 0, v5
    s_nop 1
    v_cndmask_b32 v5, v7, v20, vcc
    v_lshlrev_b32 v2, 3, v2
    v_add_u32 v2, 138368, v2
    v_mov_b32 v4, 138368
    v_and_b32 v6, 3, v0
    v_mul_u32_u24 v6, 0x5555, v6
    s_and_b32 s65, s32, 7
    s_lshl_b32 s65, s65, 15
    s_lshr_b32 s62, s32, 3
    s_lshl_b32 s62, s62, 14
    s_add_u32 s65, s65, s62
    s_lshl_b32 s62, s34, 10
    s_add_u32 s65, s65, s62
    s_lshl_b32 s62, s31, 7
    s_add_u32 s65, s65, s62
    s_add_u32 s65, s65, 131072
    s_mov_b32 s61, 0x3db8aa3b
    v_mov_b64 v[12:13], 0
    v_mov_b64 v[14:15], 0
    v_mov_b64 v[16:17], 0
    v_mov_b64 v[18:19], 0
    v_mov_b64 v[72:73], 0
    v_mov_b64 v[74:75], 0
    v_mov_b64 v[76:77], 0
    v_mov_b64 v[78:79], 0
    v_mov_b64 v[80:81], 0
    v_mov_b64 v[82:83], 0
    v_mov_b64 v[84:85], 0
    v_mov_b64 v[86:87], 0
    v_mov_b64 v[88:89], 0
    v_mov_b64 v[90:91], 0
    v_mov_b64 v[92:93], 0
    v_mov_b64 v[94:95], 0
    v_mov_b64 v[96:97], 0
    v_mov_b64 v[98:99], 0
    v_mov_b64 v[100:101], 0
    v_mov_b64 v[102:103], 0
    v_mov_b64 v[104:105], 0
    v_mov_b64 v[106:107], 0
    v_mov_b64 v[108:109], 0
    v_mov_b64 v[110:111], 0
    v_mov_b64 v[112:113], 0
    v_mov_b64 v[114:115], 0
    v_mov_b64 v[116:117], 0
    v_mov_b64 v[118:119], 0
    v_mov_b64 v[120:121], 0
    v_mov_b64 v[122:123], 0
    v_mov_b64 v[124:125], 0
    v_mov_b64 v[126:127], 0
    v_mov_b64 v[128:129], 0
    v_mov_b64 v[130:131], 0
    v_mov_b64 v[132:133], 0
    v_mov_b64 v[134:135], 0
    v_mov_b64 v[136:137], 0
    v_mov_b64 v[138:139], 0
    v_mov_b64 v[140:141], 0
    v_mov_b64 v[142:143], 0
    v_mov_b64 v[144:145], 0
    v_mov_b64 v[146:147], 0
    v_mov_b64 v[148:149], 0
    v_mov_b64 v[150:151], 0
    s_bitcmp1_b32 0xaae, s34
    s_cbranch_scc0 L_abs_19
    s_and_b32 s62, s35, 0xaae
    s_bcnt1_i32_b32 s62, s62
    s_add_u32 s62, s62, 0
    s_lshl_b32 s62, s62, 13
    s_xor_b32 s62, s62, s60
    buffer_load_dwordx4 v[72:75], v1, s[40:43], s62 offen offset:0 nt
    buffer_load_dwordx4 v[76:79], v1, s[40:43], s62 offen offset:1024 nt
L_abs_19:
    s_bitcmp1_b32 0xaae, s34
    s_cbranch_scc0 L_abs_20
    s_and_b32 s62, s35, 0xaae
    s_bcnt1_i32_b32 s62, s62
    s_add_u32 s62, s62, 7
    s_lshl_b32 s62, s62, 13
    s_xor_b32 s62, s62, s60
    buffer_load_dwordx4 v[80:83], v1, s[40:43], s62 offen offset:0 nt
    buffer_load_dwordx4 v[84:87], v1, s[40:43], s62 offen offset:1024 nt
L_abs_20:
    s_xor_b32 s60, s60, 0x2000
    s_bitcmp1_b32 0xaae, s34
    s_cbranch_scc0 L_abs_21
    s_and_b32 s62, s35, 0xaae
    s_bcnt1_i32_b32 s62, s62
    s_add_u32 s62, s62, 14
    s_lshl_b32 s62, s62, 13
    s_xor_b32 s62, s62, s60
    buffer_load_dwordx4 v[88:91], v1, s[40:43], s62 offen offset:0 nt
    buffer_load_dwordx4 v[92:95], v1, s[40:43], s62 offen offset:1024 nt
L_abs_21:
    s_bitcmp1_b32 0x3aae, s34
    s_cbranch_scc0 L_abs_22
    s_and_b32 s62, s35, 0x3aae
    s_bcnt1_i32_b32 s62, s62
    s_add_u32 s62, s62, 21
    s_lshl_b32 s62, s62, 13
    s_xor_b32 s62, s62, s60
    buffer_load_dwordx4 v[96:99], v1, s[40:43], s62 offen offset:0 nt
    buffer_load_dwordx4 v[100:103], v1, s[40:43], s62 offen offset:1024 nt
L_abs_22:
    s_xor_b32 s60, s60, 0x2000
    s_bitcmp1_b32 0x3aae, s34
    s_cbranch_scc0 L_abs_23
    s_and_b32 s62, s35, 0x3aae
    s_bcnt1_i32_b32 s62, s62
    s_add_u32 s62, s62, 30
    s_lshl_b32 s62, s62, 13
    s_xor_b32 s62, s62, s60
    buffer_load_dwordx4 v[104:107], v1, s[40:43], s62 offen offset:0 nt
    buffer_load_dwordx4 v[108:111], v1, s[40:43], s62 offen offset:1024 nt
L_abs_23:
    s_bitcmp1_b32 0x3aae, s34
    s_cbranch_scc0 L_abs_24
    s_and_b32 s62, s35, 0x3aae
    s_bcnt1_i32_b32 s62, s62
    s_add_u32 s62, s62, 39
    s_lshl_b32 s62, s62, 13
    s_xor_b32 s62, s62, s60
    buffer_load_dwordx4 v[112:115], v1, s[40:43], s62 offen offset:0 nt
    buffer_load_dwordx4 v[116:119], v1, s[40:43], s62 offen offset:1024 nt
L_abs_24:
    s_xor_b32 s60, s60, 0x2000
    s_bitcmp1_b32 0x3aee, s34
    s_cbranch_scc0 L_abs_25
    s_and_b32 s62, s35, 0x3aee
    s_bcnt1_i32_b32 s62, s62
    s_add_u32 s62, s62, 48
    s_lshl_b32 s62, s62, 13
    s_xor_b32 s62, s62, s60
    buffer_load_dwordx4 v[120:123], v1, s[40:43], s62 offen offset:0 nt
    buffer_load_dwordx4 v[124:127], v1, s[40:43], s62 offen offset:1024 nt
L_abs_25:
    s_bitcmp1_b32 0x3aee, s34
    s_cbranch_scc0 L_abs_26
    s_and_b32 s62, s35, 0x3aee
    s_bcnt1_i32_b32 s62, s62
    s_add_u32 s62, s62, 58
    s_lshl_b32 s62, s62, 13
    s_xor_b32 s62, s62, s60
    buffer_load_dwordx4 v[128:131], v1, s[40:43], s62 offen offset:0 nt
    buffer_load_dwordx4 v[132:135], v1, s[40:43], s62 offen offset:1024 nt
L_abs_26:
    s_xor_b32 s60, s60, 0x2000
    s_bitcmp1_b32 0x3aee, s34
    s_cbranch_scc0 L_abs_27
    s_and_b32 s62, s35, 0x3aee
    s_bcnt1_i32_b32 s62, s62
    s_add_u32 s62, s62, 68
    s_lshl_b32 s62, s62, 13
    s_xor_b32 s62, s62, s60
    buffer_load_dwordx4 v[136:139], v1, s[40:43], s62 offen offset:0 nt
    buffer_load_dwordx4 v[140:143], v1, s[40:43], s62 offen offset:1024 nt
L_abs_27:
    s_bitcmp1_b32 0x3aee, s34
    s_cbranch_scc0 L_abs_28
    s_and_b32 s62, s35, 0x3aee
    s_bcnt1_i32_b32 s62, s62
    s_add_u32 s62, s62, 78
    s_lshl_b32 s62, s62, 13
    s_xor_b32 s62, s62, s60
    buffer_load_dwordx4 v[144:147], v1, s[40:43], s62 offen offset:0 nt
    buffer_load_dwordx4 v[148:151], v1, s[40:43], s62 offen offset:1024 nt
L_abs_28:
    s_xor_b32 s60, s60, 0x2000
    s_add_u32 s62, s64, 0xb0000
    s_xor_b32 s62, s62, s60
    buffer_load_dwordx4 v[152:155], v1, s[40:43], s62 offen offset:0 nt
    buffer_load_dwordx4 v[156:159], v1, s[40:43], s62 offen offset:1024 nt
    s_add_u32 s62, s64, 0xcc000
    s_xor_b32 s62, s62, s60
    buffer_load_dwordx4 v[160:163], v1, s[40:43], s62 offen offset:0 nt
    buffer_load_dwordx4 v[164:167], v1, s[40:43], s62 offen offset:1024 nt
    s_xor_b32 s60, s60, 0x2000
    s_add_u32 s62, s64, 0xe8000
    s_xor_b32 s62, s62, s60
    buffer_load_dwordx4 v[168:171], v1, s[40:43], s62 offen offset:0 nt
    buffer_load_dwordx4 v[172:175], v1, s[40:43], s62 offen offset:1024 nt
    s_add_u32 s62, s64, 0x104000
    s_xor_b32 s62, s62, s60
    buffer_load_dwordx4 v[176:179], v1, s[40:43], s62 offen offset:0 nt
    buffer_load_dwordx4 v[180:183], v1, s[40:43], s62 offen offset:1024 nt
    s_xor_b32 s60, s60, 0x2000
    s_add_u32 s62, s64, 0x120000
    s_xor_b32 s62, s62, s60
    buffer_load_dwordx4 v[184:187], v1, s[40:43], s62 offen offset:0 nt
    buffer_load_dwordx4 v[188:191], v1, s[40:43], s62 offen offset:1024 nt
    s_add_u32 s62, s64, 0x13c000
    s_xor_b32 s62, s62, s60
    buffer_load_dwordx4 v[192:195], v1, s[40:43], s62 offen offset:0 nt
    buffer_load_dwordx4 v[196:199], v1, s[40:43], s62 offen offset:1024 nt
    s_xor_b32 s60, s60, 0x2000
    s_add_u32 s62, s64, 0x158000
    s_xor_b32 s62, s62, s60
    buffer_load_dwordx4 v[200:203], v1, s[40:43], s62 offen offset:0 nt
    buffer_load_dwordx4 v[204:207], v1, s[40:43], s62 offen offset:1024 nt
    s_add_u32 s62, s64, 0x174000
    s_xor_b32 s62, s62, s60
    buffer_load_dwordx4 v[208:211], v1, s[40:43], s62 offen offset:0 nt
    buffer_load_dwordx4 v[212:215], v1, s[40:43], s62 offen offset:1024 nt
    s_waitcnt lgkmcnt(0)
    s_barrier
    ds_read_b128 v[48:51], v4
    ds_read_b128 v[52:55], v4 offset:16
    ds_read_b64 v[36:37], v2
    ds_read_b64 v[38:39], v2 offset:16
    ds_read_b128 v[20:23], v3 offset:0
    ds_read_b128 v[24:27], v3 offset:768
    ds_read_b128 v[28:31], v3 offset:384
    ds_read_b128 v[32:35], v3 offset:1152
    s_waitcnt lgkmcnt(4)
    v_max3_f32 v48, v48, v49, v50
    v_max3_f32 v52, v52, v53, v54
    v_max_f32 v48, v48, v51
    v_max_f32 v52, v52, v55
    v_sub_f32 v36, v36, v48
    v_sub_f32 v37, v37, v48
    v_sub_f32 v38, v38, v52
    v_sub_f32 v39, v39, v52
    v_mul_f32 v36, s61, v36
    v_mul_f32 v37, s61, v37
    v_mul_f32 v38, s61, v38
    v_mul_f32 v39, s61, v39
    v_exp_f32 v36, v36
    v_exp_f32 v37, v37
    v_exp_f32 v38, v38
    v_exp_f32 v39, v39
    s_waitcnt lgkmcnt(0)
    v_mul_f32 v20, v20, v36
    v_mul_f32 v21, v21, v36
    v_mul_f32 v22, v22, v36
    v_mul_f32 v23, v23, v36
    v_mul_f32 v24, v24, v37
    v_mul_f32 v25, v25, v37
    v_mul_f32 v26, v26, v37
    v_mul_f32 v27, v27, v37
    v_cvt_pk_bf16_f32 v40, v20, v24
    v_cvt_pk_bf16_f32 v41, v21, v25
    v_cvt_pk_bf16_f32 v42, v22, v26
    v_cvt_pk_bf16_f32 v43, v23, v27
    v_mul_f32 v28, v28, v38
    v_mul_f32 v29, v29, v38
    v_mul_f32 v30, v30, v38
    v_mul_f32 v31, v31, v38
    v_mul_f32 v32, v32, v39
    v_mul_f32 v33, v33, v39
    v_mul_f32 v34, v34, v39
    v_mul_f32 v35, v35, v39
    v_cvt_pk_bf16_f32 v44, v28, v32
    v_cvt_pk_bf16_f32 v45, v29, v33
    v_cvt_pk_bf16_f32 v46, v30, v34
    v_cvt_pk_bf16_f32 v47, v31, v35
    ds_read_b128 v[20:23], v3 offset:16
    ds_read_b128 v[24:27], v3 offset:784
    ds_read_b128 v[28:31], v3 offset:400
    ds_read_b128 v[32:35], v3 offset:1168
    v_and_b32 v48, v40, v8
    v_and_b32 v49, v40, v9
    v_and_b32 v50, v40, v10
    v_and_b32 v51, v40, v11
    v_and_b32 v52, v44, v8
    v_and_b32 v53, v44, v9
    v_and_b32 v54, v44, v10
    v_and_b32 v55, v44, v11
    v_and_b32 v56, v41, v8
    v_and_b32 v57, v41, v9
    v_and_b32 v58, v41, v10
    v_and_b32 v59, v41, v11
    v_and_b32 v60, v45, v8
    v_and_b32 v61, v45, v9
    v_and_b32 v62, v45, v10
    v_and_b32 v63, v45, v11
    v_and_b32 v64, v42, v8
    v_and_b32 v65, v42, v9
    v_and_b32 v66, v42, v10
    v_and_b32 v67, v42, v11
    v_and_b32 v68, v46, v8
    v_and_b32 v69, v46, v9
    v_and_b32 v70, v46, v10
    v_and_b32 v71, v46, v11
    s_xor_b32 s60, s60, 0x2000
    s_add_u32 s62, s64, 0x190000
    s_xor_b32 s62, s62, s60
    buffer_load_dwordx4 v[216:219], v1, s[40:43], s62 offen offset:0 nt
    buffer_load_dwordx4 v[220:223], v1, s[40:43], s62 offen offset:1024 nt
    s_waitcnt vmcnt(36)
    v_smfmac_f32_16x16x64_bf16 v[12:15], v[48:51], v[72:79], v6
    v_smfmac_f32_16x16x64_bf16 v[16:19], v[52:55], v[72:79], v6
    s_waitcnt vmcnt(34)
    v_smfmac_f32_16x16x64_bf16 v[12:15], v[56:59], v[80:87], v6
    v_smfmac_f32_16x16x64_bf16 v[16:19], v[60:63], v[80:87], v6
    v_and_b32 v48, v43, v8
    v_and_b32 v49, v43, v9
    v_and_b32 v50, v43, v10
    v_and_b32 v51, v43, v11
    v_and_b32 v52, v47, v8
    v_and_b32 v53, v47, v9
    v_and_b32 v54, v47, v10
    v_and_b32 v55, v47, v11
    s_waitcnt lgkmcnt(0)
    v_mul_f32 v20, v20, v36
    v_mul_f32 v21, v21, v36
    v_mul_f32 v22, v22, v36
    v_mul_f32 v23, v23, v36
    v_mul_f32 v24, v24, v37
    v_mul_f32 v25, v25, v37
    v_mul_f32 v26, v26, v37
    v_mul_f32 v27, v27, v37
    v_cvt_pk_bf16_f32 v40, v20, v24
    v_cvt_pk_bf16_f32 v41, v21, v25
    v_cvt_pk_bf16_f32 v42, v22, v26
    v_cvt_pk_bf16_f32 v43, v23, v27
    v_mul_f32 v28, v28, v38
    v_mul_f32 v29, v29, v38
    v_mul_f32 v30, v30, v38
    v_mul_f32 v31, v31, v38
    v_mul_f32 v32, v32, v39
    v_mul_f32 v33, v33, v39
    v_mul_f32 v34, v34, v39
    v_mul_f32 v35, v35, v39
    v_cvt_pk_bf16_f32 v44, v28, v32
    v_cvt_pk_bf16_f32 v45, v29, v33
    v_cvt_pk_bf16_f32 v46, v30, v34
    v_cvt_pk_bf16_f32 v47, v31, v35
    ds_read_b128 v[20:23], v3 offset:32
    ds_read_b128 v[24:27], v3 offset:800
    ds_read_b128 v[28:31], v3 offset:416
    ds_read_b128 v[32:35], v3 offset:1184
    v_and_b32 v72, v40, v8
    v_and_b32 v73, v40, v9
    v_and_b32 v74, v40, v10
    v_and_b32 v75, v40, v11
    v_and_b32 v76, v44, v8
    v_and_b32 v77, v44, v9
    v_and_b32 v78, v44, v10
    v_and_b32 v79, v44, v11
    s_add_u32 s62, s64, 0x1ac000
    s_xor_b32 s62, s62, s60
    buffer_load_dwordx4 v[224:227], v1, s[40:43], s62 offen offset:0 nt
    buffer_load_dwordx4 v[228:231], v1, s[40:43], s62 offen offset:1024 nt
    s_waitcnt vmcnt(34)
    v_smfmac_f32_16x16x64_bf16 v[12:15], v[64:67], v[88:95], v6
    v_smfmac_f32_16x16x64_bf16 v[16:19], v[68:71], v[88:95], v6
    v_and_b32 v56, v41, v8
    v_and_b32 v57, v41, v9
    v_and_b32 v58, v41, v10
    v_and_b32 v59, v41, v11
    v_and_b32 v60, v45, v8
    v_and_b32 v61, v45, v9
    v_and_b32 v62, v45, v10
    v_and_b32 v63, v45, v11
    v_and_b32 v80, v42, v8
    v_and_b32 v81, v42, v9
    v_and_b32 v82, v42, v10
    v_and_b32 v83, v42, v11
    v_and_b32 v84, v46, v8
    v_and_b32 v85, v46, v9
    v_and_b32 v86, v46, v10
    v_and_b32 v87, v46, v11
    s_waitcnt vmcnt(32)
    v_smfmac_f32_16x16x64_bf16 v[12:15], v[48:51], v[96:103], v6
    v_smfmac_f32_16x16x64_bf16 v[16:19], v[52:55], v[96:103], v6
    v_and_b32 v64, v43, v8
    v_and_b32 v65, v43, v9
    v_and_b32 v66, v43, v10
    v_and_b32 v67, v43, v11
    v_and_b32 v68, v47, v8
    v_and_b32 v69, v47, v9
    v_and_b32 v70, v47, v10
    v_and_b32 v71, v47, v11
    s_waitcnt lgkmcnt(0)
    v_mul_f32 v20, v20, v36
    v_mul_f32 v21, v21, v36
    v_mul_f32 v22, v22, v36
    v_mul_f32 v23, v23, v36
    v_mul_f32 v24, v24, v37
    v_mul_f32 v25, v25, v37
    v_mul_f32 v26, v26, v37
    v_mul_f32 v27, v27, v37
    v_cvt_pk_bf16_f32 v40, v20, v24
    v_cvt_pk_bf16_f32 v41, v21, v25
    v_cvt_pk_bf16_f32 v42, v22, v26
    v_cvt_pk_bf16_f32 v43, v23, v27
    v_mul_f32 v28, v28, v38
    v_mul_f32 v29, v29, v38
    v_mul_f32 v30, v30, v38
    v_mul_f32 v31, v31, v38
    v_mul_f32 v32, v32, v39
    v_mul_f32 v33, v33, v39
    v_mul_f32 v34, v34, v39
    v_mul_f32 v35, v35, v39
    v_cvt_pk_bf16_f32 v44, v28, v32
    v_cvt_pk_bf16_f32 v45, v29, v33
    v_cvt_pk_bf16_f32 v46, v30, v34
    v_cvt_pk_bf16_f32 v47, v31, v35
    ds_read_b128 v[20:23], v3 offset:48
    ds_read_b128 v[24:27], v3 offset:816
    ds_read_b128 v[28:31], v3 offset:432
    ds_read_b128 v[32:35], v3 offset:1200
    v_and_b32 v88, v40, v8
    v_and_b32 v89, v40, v9
    v_and_b32 v90, v40, v10
    v_and_b32 v91, v40, v11
    v_and_b32 v92, v44, v8
    v_and_b32 v93, v44, v9
    v_and_b32 v94, v44, v10
    v_and_b32 v95, v44, v11
    s_xor_b32 s60, s60, 0x2000
    s_add_u32 s62, s64, 0x1c8000
    s_xor_b32 s62, s62, s60
    buffer_load_dwordx4 v[232:235], v1, s[40:43], s62 offen offset:0 nt
    buffer_load_dwordx4 v[236:239], v1, s[40:43], s62 offen offset:1024 nt
    s_waitcnt vmcnt(32)
    v_smfmac_f32_16x16x64_bf16 v[12:15], v[72:75], v[104:111], v6
    v_smfmac_f32_16x16x64_bf16 v[16:19], v[76:79], v[104:111], v6
    v_and_b32 v48, v41, v8
    v_and_b32 v49, v41, v9
    v_and_b32 v50, v41, v10
    v_and_b32 v51, v41, v11
    v_and_b32 v52, v45, v8
    v_and_b32 v53, v45, v9
    v_and_b32 v54, v45, v10
    v_and_b32 v55, v45, v11
    v_and_b32 v96, v42, v8
    v_and_b32 v97, v42, v9
    v_and_b32 v98, v42, v10
    v_and_b32 v99, v42, v11
    v_and_b32 v100, v46, v8
    v_and_b32 v101, v46, v9
    v_and_b32 v102, v46, v10
    v_and_b32 v103, v46, v11
    s_waitcnt vmcnt(30)
    v_smfmac_f32_16x16x64_bf16 v[12:15], v[56:59], v[112:119], v6
    v_smfmac_f32_16x16x64_bf16 v[16:19], v[60:63], v[112:119], v6
    v_and_b32 v72, v43, v8
    v_and_b32 v73, v43, v9
    v_and_b32 v74, v43, v10
    v_and_b32 v75, v43, v11
    v_and_b32 v76, v47, v8
    v_and_b32 v77, v47, v9
    v_and_b32 v78, v47, v10
    v_and_b32 v79, v47, v11
    s_waitcnt lgkmcnt(0)
    v_mul_f32 v20, v20, v36
    v_mul_f32 v21, v21, v36
    v_mul_f32 v22, v22, v36
    v_mul_f32 v23, v23, v36
    v_mul_f32 v24, v24, v37
    v_mul_f32 v25, v25, v37
    v_mul_f32 v26, v26, v37
    v_mul_f32 v27, v27, v37
    v_cvt_pk_bf16_f32 v40, v20, v24
    v_cvt_pk_bf16_f32 v41, v21, v25
    v_cvt_pk_bf16_f32 v42, v22, v26
    v_cvt_pk_bf16_f32 v43, v23, v27
    v_mul_f32 v28, v28, v38
    v_mul_f32 v29, v29, v38
    v_mul_f32 v30, v30, v38
    v_mul_f32 v31, v31, v38
    v_mul_f32 v32, v32, v39
    v_mul_f32 v33, v33, v39
    v_mul_f32 v34, v34, v39
    v_mul_f32 v35, v35, v39
    v_cvt_pk_bf16_f32 v44, v28, v32
    v_cvt_pk_bf16_f32 v45, v29, v33
    v_cvt_pk_bf16_f32 v46, v30, v34
    v_cvt_pk_bf16_f32 v47, v31, v35
    ds_read_b128 v[20:23], v3 offset:64
    ds_read_b128 v[24:27], v3 offset:832
    ds_read_b128 v[28:31], v3 offset:448
    ds_read_b128 v[32:35], v3 offset:1216
    v_and_b32 v104, v40, v8
    v_and_b32 v105, v40, v9
    v_and_b32 v106, v40, v10
    v_and_b32 v107, v40, v11
    v_and_b32 v108, v44, v8
    v_and_b32 v109, v44, v9
    v_and_b32 v110, v44, v10
    v_and_b32 v111, v44, v11
    s_add_u32 s62, s64, 0x1e4000
    s_xor_b32 s62, s62, s60
    buffer_load_dwordx4 v[240:243], v1, s[40:43], s62 offen offset:0 nt
    buffer_load_dwordx4 v[244:247], v1, s[40:43], s62 offen offset:1024 nt
    s_waitcnt vmcnt(30)
    v_smfmac_f32_16x16x64_bf16 v[12:15], v[80:83], v[120:127], v6
    v_smfmac_f32_16x16x64_bf16 v[16:19], v[84:87], v[120:127], v6
    v_and_b32 v56, v41, v8
    v_and_b32 v57, v41, v9
    v_and_b32 v58, v41, v10
    v_and_b32 v59, v41, v11
    v_and_b32 v60, v45, v8
    v_and_b32 v61, v45, v9
    v_and_b32 v62, v45, v10
    v_and_b32 v63, v45, v11
    v_and_b32 v112, v42, v8
    v_and_b32 v113, v42, v9
    v_and_b32 v114, v42, v10
    v_and_b32 v115, v42, v11
    v_and_b32 v116, v46, v8
    v_and_b32 v117, v46, v9
    v_and_b32 v118, v46, v10
    v_and_b32 v119, v46, v11
    s_waitcnt vmcnt(28)
    v_smfmac_f32_16x16x64_bf16 v[12:15], v[64:67], v[128:135], v6
    v_smfmac_f32_16x16x64_bf16 v[16:19], v[68:71], v[128:135], v6
    v_and_b32 v80, v43, v8
    v_and_b32 v81, v43, v9
    v_and_b32 v82, v43, v10
    v_and_b32 v83, v43, v11
    v_and_b32 v84, v47, v8
    v_and_b32 v85, v47, v9
    v_and_b32 v86, v47, v10
    v_and_b32 v87, v47, v11
    s_waitcnt lgkmcnt(0)
    v_mul_f32 v20, v20, v36
    v_mul_f32 v21, v21, v36
    v_mul_f32 v22, v22, v36
    v_mul_f32 v23, v23, v36
    v_mul_f32 v24, v24, v37
    v_mul_f32 v25, v25, v37
    v_mul_f32 v26, v26, v37
    v_mul_f32 v27, v27, v37
    v_cvt_pk_bf16_f32 v40, v20, v24
    v_cvt_pk_bf16_f32 v41, v21, v25
    v_cvt_pk_bf16_f32 v42, v22, v26
    v_cvt_pk_bf16_f32 v43, v23, v27
    v_mul_f32 v28, v28, v38
    v_mul_f32 v29, v29, v38
    v_mul_f32 v30, v30, v38
    v_mul_f32 v31, v31, v38
    v_mul_f32 v32, v32, v39
    v_mul_f32 v33, v33, v39
    v_mul_f32 v34, v34, v39
    v_mul_f32 v35, v35, v39
    v_cvt_pk_bf16_f32 v44, v28, v32
    v_cvt_pk_bf16_f32 v45, v29, v33
    v_cvt_pk_bf16_f32 v46, v30, v34
    v_cvt_pk_bf16_f32 v47, v31, v35
    ds_read_b128 v[20:23], v3 offset:80
    ds_read_b128 v[24:27], v3 offset:848
    ds_read_b128 v[28:31], v3 offset:464
    ds_read_b128 v[32:35], v3 offset:1232
    v_and_b32 v120, v40, v8
    v_and_b32 v121, v40, v9
    v_and_b32 v122, v40, v10
    v_and_b32 v123, v40, v11
    v_and_b32 v124, v44, v8
    v_and_b32 v125, v44, v9
    v_and_b32 v126, v44, v10
    v_and_b32 v127, v44, v11
    s_waitcnt vmcnt(26)
    v_smfmac_f32_16x16x64_bf16 v[12:15], v[88:91], v[136:143], v6
    v_smfmac_f32_16x16x64_bf16 v[16:19], v[92:95], v[136:143], v6
    v_and_b32 v64, v41, v8
    v_and_b32 v65, v41, v9
    v_and_b32 v66, v41, v10
    v_and_b32 v67, v41, v11
    v_and_b32 v68, v45, v8
    v_and_b32 v69, v45, v9
    v_and_b32 v70, v45, v10
    v_and_b32 v71, v45, v11
    v_and_b32 v128, v42, v8
    v_and_b32 v129, v42, v9
    v_and_b32 v130, v42, v10
    v_and_b32 v131, v42, v11
    v_and_b32 v132, v46, v8
    v_and_b32 v133, v46, v9
    v_and_b32 v134, v46, v10
    v_and_b32 v135, v46, v11
    s_waitcnt vmcnt(24)
    v_smfmac_f32_16x16x64_bf16 v[12:15], v[48:51], v[144:151], v6
    v_smfmac_f32_16x16x64_bf16 v[16:19], v[52:55], v[144:151], v6
    v_and_b32 v88, v43, v8
    v_and_b32 v89, v43, v9
    v_and_b32 v90, v43, v10
    v_and_b32 v91, v43, v11
    v_and_b32 v92, v47, v8
    v_and_b32 v93, v47, v9
    v_and_b32 v94, v47, v10
    v_and_b32 v95, v47, v11
    s_waitcnt lgkmcnt(0)
    v_mul_f32 v20, v20, v36
    v_mul_f32 v21, v21, v36
    v_mul_f32 v24, v24, v37
    v_mul_f32 v25, v25, v37
    v_cvt_pk_bf16_f32 v40, v20, v24
    v_cvt_pk_bf16_f32 v41, v21, v25
    v_mul_f32 v28, v28, v38
    v_mul_f32 v29, v29, v38
    v_mul_f32 v32, v32, v39
    v_mul_f32 v33, v33, v39
    v_cvt_pk_bf16_f32 v44, v28, v32
    v_cvt_pk_bf16_f32 v45, v29, v33
    v_and_b32 v136, v40, v8
    v_and_b32 v137, v40, v9
    v_and_b32 v138, v40, v10
    v_and_b32 v139, v40, v11
    v_and_b32 v140, v44, v8
    v_and_b32 v141, v44, v9
    v_and_b32 v142, v44, v10
    v_and_b32 v143, v44, v11
    s_waitcnt vmcnt(22)
    v_smfmac_f32_16x16x64_bf16 v[12:15], v[96:99], v[152:159], v6
    v_smfmac_f32_16x16x64_bf16 v[16:19], v[100:103], v[152:159], v6
    v_and_b32 v48, v41, v8
    v_and_b32 v49, v41, v9
    v_and_b32 v50, v41, v10
    v_and_b32 v51, v41, v11
    v_and_b32 v52, v45, v8
    v_and_b32 v53, v45, v9
    v_and_b32 v54, v45, v10
    v_and_b32 v55, v45, v11
    s_waitcnt vmcnt(20)
    v_smfmac_f32_16x16x64_bf16 v[12:15], v[72:75], v[160:167], v6
    v_smfmac_f32_16x16x64_bf16 v[16:19], v[76:79], v[160:167], v6
    s_waitcnt vmcnt(18)
    v_smfmac_f32_16x16x64_bf16 v[12:15], v[104:107], v[168:175], v6
    v_smfmac_f32_16x16x64_bf16 v[16:19], v[108:111], v[168:175], v6
    s_waitcnt vmcnt(16)
    v_smfmac_f32_16x16x64_bf16 v[12:15], v[56:59], v[176:183], v6
    v_smfmac_f32_16x16x64_bf16 v[16:19], v[60:63], v[176:183], v6
    s_waitcnt vmcnt(14)
    v_smfmac_f32_16x16x64_bf16 v[12:15], v[112:115], v[184:191], v6
    v_smfmac_f32_16x16x64_bf16 v[16:19], v[116:119], v[184:191], v6
    s_waitcnt vmcnt(12)
    v_smfmac_f32_16x16x64_bf16 v[12:15], v[80:83], v[192:199], v6
    v_smfmac_f32_16x16x64_bf16 v[16:19], v[84:87], v[192:199], v6
    s_waitcnt vmcnt(10)
    v_smfmac_f32_16x16x64_bf16 v[12:15], v[120:123], v[200:207], v6
    v_smfmac_f32_16x16x64_bf16 v[16:19], v[124:127], v[200:207], v6
    s_waitcnt vmcnt(8)
    v_smfmac_f32_16x16x64_bf16 v[12:15], v[64:67], v[208:215], v6
    v_smfmac_f32_16x16x64_bf16 v[16:19], v[68:71], v[208:215], v6
    s_waitcnt vmcnt(6)
    v_smfmac_f32_16x16x64_bf16 v[12:15], v[128:131], v[216:223], v6
    v_smfmac_f32_16x16x64_bf16 v[16:19], v[132:135], v[216:223], v6
    s_waitcnt vmcnt(4)
    v_smfmac_f32_16x16x64_bf16 v[12:15], v[88:91], v[224:231], v6
    v_smfmac_f32_16x16x64_bf16 v[16:19], v[92:95], v[224:231], v6
    s_waitcnt vmcnt(2)
    v_smfmac_f32_16x16x64_bf16 v[12:15], v[136:139], v[232:239], v6
    v_smfmac_f32_16x16x64_bf16 v[16:19], v[140:143], v[232:239], v6
    s_waitcnt vmcnt(0)
    v_smfmac_f32_16x16x64_bf16 v[12:15], v[48:51], v[240:247], v6
    v_smfmac_f32_16x16x64_bf16 v[16:19], v[52:55], v[240:247], v6
    s_nop 7
    v_permlane32_swap_b32 v12, v16
    v_permlane32_swap_b32 v13, v17
    v_permlane32_swap_b32 v14, v18
    v_permlane32_swap_b32 v15, v19
    v_add_f32_dpp v12, v16, v12 row_ror:8 row_mask:0xf bank_mask:0xf
    v_add_f32_dpp v13, v17, v13 row_ror:8 row_mask:0xf bank_mask:0xf
    v_add_f32_dpp v14, v18, v14 row_ror:8 row_mask:0xf bank_mask:0xf
    v_add_f32_dpp v15, v19, v15 row_ror:8 row_mask:0xf bank_mask:0xf
    v_cvt_pk_bf16_f32 v16, v12, v13
    v_cvt_pk_bf16_f32 v17, v14, v15
    v_min_u32 v16, -2, v16
    v_min_u32 v17, -2, v17
    buffer_store_dwordx2 v[16:17], v5, s[44:47], s65 offen sc1
L_vend:
    s_endpgm
L_mjob0:
    s_and_b32 s37, s35, 0x40
    s_bcnt1_i32_b32 s37, s37
    s_lshl4_add_u32 s37, s37, s32
    s_add_u32 s37, s37, 14
    s_mov_b32 s36, 64
L_mjob:
    v_mul_u32_u24 v9, 5376, v250
    v_add_u32 v9, v9, v251
    s_lshl_b32 s60, s37, 7
    s_mul_i32 s61, s31, 602112
    s_add_u32 s60, s60, s61
    s_mul_i32 s61, s31, 14336
    s_waitcnt lgkmcnt(0)
    s_mov_b32 s48, s24
    s_mov_b32 s49, s25
    s_mov_b32 s50, 0x24c000
    s_mov_b32 s51, 0x20000
    s_mov_b32 m0, s61
    s_add_u32 s61, s61, 1024
    buffer_load_dwordx4 v9, s[48:51], s60 offen nt lds
    s_add_u32 s60, s60, 43008
    s_mov_b32 m0, s61
    s_add_u32 s61, s61, 1024
    buffer_load_dwordx4 v9, s[48:51], s60 offen nt lds
    s_add_u32 s60, s60, 43008
    s_lshl_b32 s62, s31, 6
    v_add_u32 v4, s62, v0
    v_lshlrev_b32 v2, 3, v4
    s_mov_b32 s52, s22
    s_mov_b32 s53, s23
    s_mov_b32 s54, 0x700
    s_mov_b32 s55, 0x20000
    buffer_load_dwordx2 v[16:17], v2, s[52:55], 0 offen
    s_mov_b32 m0, s61
    s_add_u32 s61, s61, 1024
    buffer_load_dwordx4 v9, s[48:51], s60 offen nt lds
    s_add_u32 s60, s60, 43008
    s_mov_b32 m0, s61
    s_add_u32 s61, s61, 1024
    buffer_load_dwordx4 v9, s[48:51], s60 offen nt lds
    s_add_u32 s60, s60, 43008
    s_mov_b32 m0, s61
    s_add_u32 s61, s61, 1024
    buffer_load_dwordx4 v9, s[48:51], s60 offen nt lds
    s_add_u32 s60, s60, 43008
    s_mov_b32 m0, s61
    s_add_u32 s61, s61, 1024
    buffer_load_dwordx4 v9, s[48:51], s60 offen nt lds
    s_add_u32 s60, s60, 43008
    s_mov_b32 m0, s61
    s_add_u32 s61, s61, 1024
    buffer_load_dwordx4 v9, s[48:51], s60 offen nt lds
    s_add_u32 s60, s60, 43008
    s_mov_b32 m0, s61
    s_add_u32 s61, s61, 1024
    buffer_load_dwordx4 v9, s[48:51], s60 offen nt lds
    s_add_u32 s60, s60, 43008
    s_mov_b32 m0, s61
    s_add_u32 s61, s61, 1024
    buffer_load_dwordx4 v9, s[48:51], s60 offen nt lds
    s_add_u32 s60, s60, 43008
    s_mov_b32 m0, s61
    s_add_u32 s61, s61, 1024
    buffer_load_dwordx4 v9, s[48:51], s60 offen nt lds
    s_add_u32 s60, s60, 43008
    s_mov_b32 m0, s61
    s_add_u32 s61, s61, 1024
    buffer_load_dwordx4 v9, s[48:51], s60 offen nt lds
    s_add_u32 s60, s60, 43008
    s_mov_b32 m0, s61
    s_add_u32 s61, s61, 1024
    buffer_load_dwordx4 v9, s[48:51], s60 offen nt lds
    s_add_u32 s60, s60, 43008
    s_mov_b32 m0, s61
    s_add_u32 s61, s61, 1024
    buffer_load_dwordx4 v9, s[48:51], s60 offen nt lds
    s_add_u32 s60, s60, 43008
    s_mov_b32 m0, s61
    s_nop 0
    buffer_load_dwordx4 v9, s[48:51], s60 offen nt lds
    s_barrier
    s_mov_b32 s39, 1000000
    s_mov_b32 s66, -1
    s_mov_b32 s67, 0x00ffffff
    v_mov_b32 v7, 0x40000000
    s_waitcnt lgkmcnt(0)
    s_load_dword s38, s[28:29], 0
    s_mov_b32 s44, s28
    s_mov_b32 s45, s29
    s_mov_b32 s46, 0x100000
    s_mov_b32 s47, 0x20000
    v_cmp_le_u32 vcc, 112, v4
    v_subrev_u32 v5, 112, v4
    s_nop 0
    v_cndmask_b32 v5, v4, v5, vcc
    v_mov_b32 v10, 131072
    v_mov_b32 v8, 133184
    v_cndmask_b32 v10, v10, v8, vcc
    v_lshrrev_b32 v2, 3, v5
    v_lshlrev_b32 v2, 6, v2
    v_and_b32 v8, 3, v5
    v_lshl_add_u32 v2, v8, 4, v2
    v_bfe_u32 v8, v5, 2, 1
    v_lshl_add_u32 v2, v8, 3, v2
    v_add_u32 v2, v2, v10
    v_mov_b32 v8, 139072
    v_cmp_gt_u32 vcc, 224, v4
    s_nop 1
    v_cndmask_b32 v2, v8, v2, vcc
    s_mov_b32 s62, 0xbfb8aa3b
    s_waitcnt vmcnt(12)
    v_lshlrev_b32 v20, 16, v16
    v_and_b32 v21, 0xffff0000, v16
    v_lshlrev_b32 v22, 16, v17
    v_and_b32 v23, 0xffff0000, v17
    v_mul_f32 v24, s62, v20
    v_mul_f32 v25, s62, v21
    v_mul_f32 v26, s62, v22
    v_mul_f32 v27, s62, v23
    v_exp_f32 v24, v24
    v_exp_f32 v25, v25
    v_exp_f32 v26, v26
    v_exp_f32 v27, v27
    v_add_f32 v24, 1.0, v24
    v_add_f32 v25, 1.0, v25
    v_add_f32 v26, 1.0, v26
    v_add_f32 v27, 1.0, v27
    v_rcp_f32 v24, v24
    v_rcp_f32 v25, v25
    v_rcp_f32 v26, v26
    v_rcp_f32 v27, v27
    v_mul_f32 v20, v20, v24
    v_mul_f32 v21, v21, v25
    v_mul_f32 v22, v22, v26
    v_mul_f32 v23, v23, v27
    v_cvt_pk_bf16_f32 v16, v20, v21
    v_cvt_pk_bf16_f32 v17, v22, v23
    ds_write_b64 v2, v[16:17]
    v_lshrrev_b32 v2, 2, v0
    v_lshlrev_b32 v1, 7, v2
    v_and_b32 v2, 6, v2
    s_lshl_b32 s60, s31, 1
    v_xor_b32 v2, s60, v2
    v_lshlrev_b32 v2, 4, v2
    v_and_b32 v3, 3, v0
    v_lshl_add_u32 v2, v3, 3, v2
    v_add_u32 v1, v1, v2
    v_and_b32 v2, 1, v0
    v_mul_u32_u24 v3, 2112, v2
    v_lshrrev_b32 v2, 4, v0
    v_lshl_add_u32 v3, v2, 4, v3
    v_add_u32 v3, 131072, v3
    v_lshlrev_b32 v2, 3, v0
    v_cmp_gt_u32 vcc, 16, v0
    s_nop 1
    v_cndmask_b32 v2, v7, v2, vcc
    s_waitcnt lgkmcnt(0)
    s_mul_i32 s38, s38, 0x9e3779b1
    s_add_u32 s38, s38, 0x7f4a7c15
    s_mov_b32 s88, 65536
L_mloop:
    s_lshl_b32 s65, s37, 9
    s_lshl_b32 s61, s31, 7
    s_add_u32 s65, s65, s61
    s_add_u32 s65, s65, 4096
    v_mov_b32 v21, s38
    s_add_u32 s37, s37, s36
    s_cmp_ge_u32 s37, 42
    s_cbranch_scc1 L_mlast
    s_lshl_b32 s60, s37, 7
    s_mul_i32 s61, s31, 602112
    s_add_u32 s60, s60, s61
    s_mul_i32 s61, s31, 14336
    s_add_u32 s61, s61, s88
    s_mov_b32 m0, s61
    s_add_u32 s61, s61, 1024
    buffer_load_dwordx4 v9, s[48:51], s60 offen nt lds
    s_add_u32 s60, s60, 43008
    s_mov_b32 m0, s61
    s_add_u32 s61, s61, 1024
    buffer_load_dwordx4 v9, s[48:51], s60 offen nt lds
    s_add_u32 s60, s60, 43008
    s_mov_b32 m0, s61
    s_add_u32 s61, s61, 1024
    buffer_load_dwordx4 v9, s[48:51], s60 offen nt lds
    s_add_u32 s60, s60, 43008
    s_mov_b32 m0, s61
    s_add_u32 s61, s61, 1024
    buffer_load_dwordx4 v9, s[48:51], s60 offen nt lds
    s_add_u32 s60, s60, 43008
    s_mov_b32 m0, s61
    s_add_u32 s61, s61, 1024
    buffer_load_dwordx4 v9, s[48:51], s60 offen nt lds
    s_add_u32 s60, s60, 43008
    s_mov_b32 m0, s61
    s_add_u32 s61, s61, 1024
    buffer_load_dwordx4 v9, s[48:51], s60 offen nt lds
    s_add_u32 s60, s60, 43008
    s_mov_b32 m0, s61
    s_add_u32 s61, s61, 1024
    buffer_load_dwordx4 v9, s[48:51], s60 offen nt lds
    s_add_u32 s60, s60, 43008
    s_mov_b32 m0, s61
    s_add_u32 s61, s61, 1024
    buffer_load_dwordx4 v9, s[48:51], s60 offen nt lds
    s_add_u32 s60, s60, 43008
    s_mov_b32 m0, s61
    s_add_u32 s61, s61, 1024
    buffer_load_dwordx4 v9, s[48:51], s60 offen nt lds
    s_add_u32 s60, s60, 43008
    s_mov_b32 m0, s61
    s_add_u32 s61, s61, 1024
    buffer_load_dwordx4 v9, s[48:51], s60 offen nt lds
    s_add_u32 s60, s60, 43008
    s_mov_b32 m0, s61
    s_add_u32 s61, s61, 1024
    buffer_load_dwordx4 v9, s[48:51], s60 offen nt lds
    s_add_u32 s60, s60, 43008
    s_mov_b32 m0, s61
    s_add_u32 s61, s61, 1024
    buffer_load_dwordx4 v9, s[48:51], s60 offen nt lds
    s_add_u32 s60, s60, 43008
    s_mov_b32 m0, s61
    s_add_u32 s61, s61, 1024
    buffer_load_dwordx4 v9, s[48:51], s60 offen nt lds
    s_add_u32 s60, s60, 43008
    s_mov_b32 m0, s61
    s_nop 0
    buffer_load_dwordx4 v9, s[48:51], s60 offen nt lds
    s_waitcnt vmcnt(14)
    s_branch L_mgo
L_mlast:
    s_waitcnt vmcnt(0)
L_mgo:
    s_barrier
    ds_read_b128 v[32:35], v3 offset:0
    ds_read_b64_tr_b16 v[128:129], v1 offset:0
    ds_read_b64_tr_b16 v[130:131], v1 offset:2048
    ds_read_b128 v[36:39], v3 offset:64
    ds_read_b64_tr_b16 v[132:133], v1 offset:4096
    ds_read_b64_tr_b16 v[134:135], v1 offset:6144
    ds_read_b128 v[40:43], v3 offset:128
    ds_read_b64_tr_b16 v[136:137], v1 offset:8192
    ds_read_b64_tr_b16 v[138:139], v1 offset:10240
    ds_read_b128 v[44:47], v3 offset:192
    ds_read_b64_tr_b16 v[140:141], v1 offset:12288
    ds_read_b64_tr_b16 v[142:143], v1 offset:14336
    s_waitcnt lgkmcnt(9)
    v_mfma_f32_16x16x32_bf16 v[16:19], v[32:35], v[128:131], 0
    ds_read_b128 v[48:51], v3 offset:256
    ds_read_b64_tr_b16 v[144:145], v1 offset:16384
    ds_read_b64_tr_b16 v[146:147], v1 offset:18432
    s_waitcnt lgkmcnt(9)
    v_mfma_f32_16x16x32_bf16 v[16:19], v[36:39], v[132:135], v[16:19]
    ds_read_b128 v[52:55], v3 offset:320
    ds_read_b64_tr_b16 v[148:149], v1 offset:20480
    ds_read_b64_tr_b16 v[150:151], v1 offset:22528
    s_waitcnt lgkmcnt(9)
    v_mfma_f32_16x16x32_bf16 v[16:19], v[40:43], v[136:139], v[16:19]
    ds_read_b128 v[56:59], v3 offset:384
    ds_read_b64_tr_b16 v[152:153], v1 offset:24576
    ds_read_b64_tr_b16 v[154:155], v1 offset:26624
    s_waitcnt lgkmcnt(9)
    v_mfma_f32_16x16x32_bf16 v[16:19], v[44:47], v[140:143], v[16:19]
    ds_read_b128 v[60:63], v3 offset:448
    ds_read_b64_tr_b16 v[156:157], v1 offset:28672
    ds_read_b64_tr_b16 v[158:159], v1 offset:30720
    s_waitcnt lgkmcnt(9)
    v_mfma_f32_16x16x32_bf16 v[16:19], v[48:51], v[144:147], v[16:19]
    ds_read_b128 v[64:67], v3 offset:512
    ds_read_b64_tr_b16 v[160:161], v1 offset:32768
    ds_read_b64_tr_b16 v[162:163], v1 offset:34816
    s_waitcnt lgkmcnt(9)
    v_mfma_f32_16x16x32_bf16 v[16:19], v[52:55], v[148:151], v[16:19]
    ds_read_b128 v[68:71], v3 offset:576
    ds_read_b64_tr_b16 v[164:165], v1 offset:36864
    ds_read_b64_tr_b16 v[166:167], v1 offset:38912
    s_waitcnt lgkmcnt(9)
    v_mfma_f32_16x16x32_bf16 v[16:19], v[56:59], v[152:155], v[16:19]
    ds_read_b128 v[72:75], v3 offset:640
    ds_read_b64_tr_b16 v[168:169], v1 offset:40960
    ds_read_b64_tr_b16 v[170:171], v1 offset:43008
    s_waitcnt lgkmcnt(9)
    v_mfma_f32_16x16x32_bf16 v[16:19], v[60:63], v[156:159], v[16:19]
    ds_read_b128 v[76:79], v3 offset:704
    ds_read_b64_tr_b16 v[172:173], v1 offset:45056
    ds_read_b64_tr_b16 v[174:175], v1 offset:47104
    s_waitcnt lgkmcnt(9)
    v_mfma_f32_16x16x32_bf16 v[16:19], v[64:67], v[160:163], v[16:19]
    ds_read_b128 v[80:83], v3 offset:768
    ds_read_b64_tr_b16 v[176:177], v1 offset:49152
    ds_read_b64_tr_b16 v[178:179], v1 offset:51200
    s_waitcnt lgkmcnt(9)
    v_mfma_f32_16x16x32_bf16 v[16:19], v[68:71], v[164:167], v[16:19]
    ds_read_b128 v[84:87], v3 offset:832
    ds_read_b64_tr_b16 v[180:181], v1 offset:53248
    ds_read_b64_tr_b16 v[182:183], v1 offset:55296
    s_waitcnt lgkmcnt(9)
    v_mfma_f32_16x16x32_bf16 v[16:19], v[72:75], v[168:171], v[16:19]
    s_waitcnt lgkmcnt(6)
    v_mfma_f32_16x16x32_bf16 v[16:19], v[76:79], v[172:175], v[16:19]
    s_waitcnt lgkmcnt(3)
    v_mfma_f32_16x16x32_bf16 v[16:19], v[80:83], v[176:179], v[16:19]
    s_waitcnt lgkmcnt(0)
    v_mfma_f32_16x16x32_bf16 v[16:19], v[84:87], v[180:183], v[16:19]
    s_nop 7
    v_cvt_pk_bf16_f32 v20, v16, v17
    buffer_store_dwordx2 v[20:21], v2, s[44:47], s65 offen sc1
    s_barrier
    s_cmp_eq_u32 s36, 64
    s_cbranch_scc1 L_vstream
    s_cmp_ge_u32 s37, 42
    s_cbranch_scc1 L_end
    s_xor_b32 s88, s88, 65536
    v_xor_b32 v1, 65536, v1
    s_branch L_mloop
L_qjob:
    s_and_b32 s37, s35, 0x511
    s_bcnt1_i32_b32 s37, s37
    s_xor_b32 s37, s37, 2
    s_and_b32 s60, s32, 1
    s_lshl1_add_u32 s37, s37, s60
    s_lshr_b32 s60, s32, 1
    s_lshl3_add_u32 s37, s60, s37
    v_mul_u32_u24 v1, 8192, v250
    v_add_u32 v1, v1, v251
    s_lshl_b32 s60, s37, 7
    s_mul_i32 s61, s31, 917504
    s_add_u32 s60, s60, s61
    s_mul_i32 s61, s31, 14336
    s_waitcnt lgkmcnt(0)
    s_mov_b32 s48, s10
    s_mov_b32 s49, s11
    s_mov_b32 s50, 0x380000
    s_mov_b32 s51, 0x20000
    s_mov_b32 m0, s61
    s_add_u32 s61, s61, 1024
    buffer_load_dwordx4 v1, s[48:51], s60 offen nt lds
    s_add_u32 s60, s60, 65536
    s_mov_b32 m0, s61
    s_add_u32 s61, s61, 1024
    buffer_load_dwordx4 v1, s[48:51], s60 offen nt lds
    s_add_u32 s60, s60, 65536
    s_mov_b32 s39, 1000000
    s_mov_b32 s66, -1
    s_mov_b32 s67, 0x00ffffff
    v_mov_b32 v7, 0x40000000
    v_lshlrev_b32 v4, 4, v0
    v_cndmask_b32 v4, v7, v4, s[66:67]
    v_lshlrev_b32 v2, 1, v0
    v_cndmask_b32 v2, v7, v2, s[66:67]
    s_mul_i32 s62, s31, 224
    s_mov_b32 s52, s4
    s_mov_b32 s53, s5
    s_mov_b32 s54, 0x700
    s_mov_b32 s55, 0x20000
    buffer_load_dwordx4 v[16:19], v4, s[52:55], 0 offen
    buffer_load_dwordx4 v[20:23], v4, s[52:55], 0 offen offset:896
    buffer_load_ushort v100, v2, s[52:55], s62 offen offset:0
    buffer_load_ushort v101, v2, s[52:55], s62 offen offset:112
    buffer_load_ushort v102, v2, s[52:55], s62 offen offset:896
    buffer_load_ushort v103, v2, s[52:55], s62 offen offset:1008
    s_mov_b32 m0, s61
    s_add_u32 s61, s61, 1024
    buffer_load_dwordx4 v1, s[48:51], s60 offen nt lds
    s_add_u32 s60, s60, 65536
    s_mov_b32 m0, s61
    s_add_u32 s61, s61, 1024
    buffer_load_dwordx4 v1, s[48:51], s60 offen nt lds
    s_add_u32 s60, s60, 65536
    s_mov_b32 m0, s61
    s_add_u32 s61, s61, 1024
    buffer_load_dwordx4 v1, s[48:51], s60 offen nt lds
    s_add_u32 s60, s60, 65536
    s_mov_b32 m0, s61
    s_add_u32 s61, s61, 1024
    buffer_load_dwordx4 v1, s[48:51], s60 offen nt lds
    s_add_u32 s60, s60, 65536
    s_mov_b32 m0, s61
    s_add_u32 s61, s61, 1024
    buffer_load_dwordx4 v1, s[48:51], s60 offen nt lds
    s_add_u32 s60, s60, 65536
    s_mov_b32 m0, s61
    s_add_u32 s61, s61, 1024
    buffer_load_dwordx4 v1, s[48:51], s60 offen nt lds
    s_add_u32 s60, s60, 65536
    s_mov_b32 m0, s61
    s_add_u32 s61, s61, 1024
    buffer_load_dwordx4 v1, s[48:51], s60 offen nt lds
    s_add_u32 s60, s60, 65536
    s_mov_b32 m0, s61
    s_add_u32 s61, s61, 1024
    buffer_load_dwordx4 v1, s[48:51], s60 offen nt lds
    s_add_u32 s60, s60, 65536
    s_mov_b32 m0, s61
    s_add_u32 s61, s61, 1024
    buffer_load_dwordx4 v1, s[48:51], s60 offen nt lds
    s_add_u32 s60, s60, 65536
    s_mov_b32 m0, s61
    s_add_u32 s61, s61, 1024
    buffer_load_dwordx4 v1, s[48:51], s60 offen nt lds
    s_add_u32 s60, s60, 65536
    s_mov_b32 m0, s61
    s_add_u32 s61, s61, 1024
    buffer_load_dwordx4 v1, s[48:51], s60 offen nt lds
    s_add_u32 s60, s60, 65536
    s_mov_b32 m0, s61
    s_nop 0
    buffer_load_dwordx4 v1, s[48:51], s60 offen nt lds
    s_waitcnt lgkmcnt(0)
    s_load_dword s38, s[28:29], 0
    s_mov_b32 s44, s28
    s_mov_b32 s45, s29
    s_mov_b32 s46, 0x100000
    s_mov_b32 s47, 0x20000
    s_mov_b32 s61, 0x3b124925
    s_waitcnt vmcnt(12)
    v_lshlrev_b32 v32, 16, v16
    v_and_b32 v33, 0xffff0000, v16
    v_lshlrev_b32 v34, 16, v17
    v_and_b32 v35, 0xffff0000, v17
    v_lshlrev_b32 v36, 16, v18
    v_and_b32 v37, 0xffff0000, v18
    v_lshlrev_b32 v38, 16, v19
    v_and_b32 v39, 0xffff0000, v19
    v_lshlrev_b32 v40, 16, v20
    v_and_b32 v41, 0xffff0000, v20
    v_lshlrev_b32 v42, 16, v21
    v_and_b32 v43, 0xffff0000, v21
    v_lshlrev_b32 v44, 16, v22
    v_and_b32 v45, 0xffff0000, v22
    v_lshlrev_b32 v46, 16, v23
    v_and_b32 v47, 0xffff0000, v23
    v_add_f32 v48, v32, v33
    v_add_f32 v48, v48, v34
    v_add_f32 v48, v48, v35
    v_add_f32 v48, v48, v36
    v_add_f32 v48, v48, v37
    v_add_f32 v48, v48, v38
    v_add_f32 v48, v48, v39
    v_add_f32 v49, v40, v41
    v_add_f32 v49, v49, v42
    v_add_f32 v49, v49, v43
    v_add_f32 v49, v49, v44
    v_add_f32 v49, v49, v45
    v_add_f32 v49, v49, v46
    v_add_f32 v49, v49, v47
    v_add_f32_dpp v48, v48, v48 row_ror:8 row_mask:0xf bank_mask:0xf
    s_nop 0
    v_add_f32_dpp v49, v49, v49 row_ror:8 row_mask:0xf bank_mask:0xf
    v_add_f32_dpp v48, v48, v48 row_ror:4 row_mask:0xf bank_mask:0xf
    s_nop 0
    v_add_f32_dpp v49, v49, v49 row_ror:4 row_mask:0xf bank_mask:0xf
    v_add_f32_dpp v48, v48, v48 row_ror:2 row_mask:0xf bank_mask:0xf
    s_nop 0
    v_add_f32_dpp v49, v49, v49 row_ror:2 row_mask:0xf bank_mask:0xf
    v_add_f32_dpp v48, v48, v48 row_ror:1 row_mask:0xf bank_mask:0xf
    s_nop 0
    v_add_f32_dpp v49, v49, v49 row_ror:1 row_mask:0xf bank_mask:0xf
    v_mov_b32 v52, v48
    v_mov_b32 v53, v49
    s_nop 0
    v_permlane16_swap_b32 v48, v52
    v_permlane16_swap_b32 v49, v53
    v_add_f32 v48, v48, v52
    v_add_f32 v49, v49, v53
    v_mov_b32 v52, v48
    v_mov_b32 v53, v49
    s_nop 0
    v_permlane32_swap_b32 v48, v52
    v_permlane32_swap_b32 v49, v53
    v_add_f32 v48, v48, v52
    v_add_f32 v49, v49, v53
    v_mul_f32 v48, s61, v48
    v_sub_f32 v32, v32, v48
    v_sub_f32 v33, v33, v48
    v_sub_f32 v34, v34, v48
    v_sub_f32 v35, v35, v48
    v_sub_f32 v36, v36, v48
    v_sub_f32 v37, v37, v48
    v_sub_f32 v38, v38, v48
    v_sub_f32 v39, v39, v48
    v_mul_f32 v50, v32, v32
    v_fmac_f32 v50, v33, v33
    v_fmac_f32 v50, v34, v34
    v_fmac_f32 v50, v35, v35
    v_fmac_f32 v50, v36, v36
    v_fmac_f32 v50, v37, v37
    v_fmac_f32 v50, v38, v38
    v_fmac_f32 v50, v39, v39
    v_cndmask_b32 v50, 0, v50, s[66:67]
    v_mul_f32 v49, s61, v49
    v_sub_f32 v40, v40, v49
    v_sub_f32 v41, v41, v49
    v_sub_f32 v42, v42, v49
    v_sub_f32 v43, v43, v49
    v_sub_f32 v44, v44, v49
    v_sub_f32 v45, v45, v49
    v_sub_f32 v46, v46, v49
    v_sub_f32 v47, v47, v49
    v_mul_f32 v51, v40, v40
    v_fmac_f32 v51, v41, v41
    v_fmac_f32 v51, v42, v42
    v_fmac_f32 v51, v43, v43
    v_fmac_f32 v51, v44, v44
    v_fmac_f32 v51, v45, v45
    v_fmac_f32 v51, v46, v46
    v_fmac_f32 v51, v47, v47
    v_cndmask_b32 v51, 0, v51, s[66:67]
    v_add_f32_dpp v50, v50, v50 row_ror:8 row_mask:0xf bank_mask:0xf
    s_nop 0
    v_add_f32_dpp v51, v51, v51 row_ror:8 row_mask:0xf bank_mask:0xf
    v_add_f32_dpp v50, v50, v50 row_ror:4 row_mask:0xf bank_mask:0xf
    s_nop 0
    v_add_f32_dpp v51, v51, v51 row_ror:4 row_mask:0xf bank_mask:0xf
    v_add_f32_dpp v50, v50, v50 row_ror:2 row_mask:0xf bank_mask:0xf
    s_nop 0
    v_add_f32_dpp v51, v51, v51 row_ror:2 row_mask:0xf bank_mask:0xf
    v_add_f32_dpp v50, v50, v50 row_ror:1 row_mask:0xf bank_mask:0xf
    s_nop 0
    v_add_f32_dpp v51, v51, v51 row_ror:1 row_mask:0xf bank_mask:0xf
    v_mov_b32 v52, v50
    v_mov_b32 v53, v51
    s_nop 0
    v_permlane16_swap_b32 v50, v52
    v_permlane16_swap_b32 v51, v53
    v_add_f32 v50, v50, v52
    v_add_f32 v51, v51, v53
    v_mov_b32 v52, v50
    v_mov_b32 v53, v51
    s_nop 0
    v_permlane32_swap_b32 v50, v52
    v_permlane32_swap_b32 v51, v53
    v_add_f32 v50, v50, v52
    v_add_f32 v51, v51, v53
    v_mul_f32 v50, s61, v50
    v_mul_f32 v51, s61, v51
    v_cvt_pk_bf16_f32 v52, v48, v49
    v_cvt_pk_bf16_f32 v53, v50, v51
    v_lshlrev_b32 v48, 16, v52
    v_and_b32 v49, 0xffff0000, v52
    v_lshlrev_b32 v50, 16, v53
    v_and_b32 v51, 0xffff0000, v53
    v_add_f32 v50, 0x3727c5ac, v50
    v_add_f32 v51, 0x3727c5ac, v51
    v_cvt_pk_bf16_f32 v52, v50, v51
    v_lshlrev_b32 v50, 16, v52
    v_and_b32 v51, 0xffff0000, v52
    v_sqrt_f32 v50, v50
    v_sqrt_f32 v51, v51
    s_nop 0
    v_cvt_pk_bf16_f32 v52, v50, v51
    v_lshlrev_b32 v50, 16, v52
    v_and_b32 v51, 0xffff0000, v52
    v_rcp_f32 v50, v50
    v_rcp_f32 v51, v51
    v_lshlrev_b32 v100, 16, v100
    v_lshlrev_b32 v101, 16, v101
    v_lshlrev_b32 v102, 16, v102
    v_lshlrev_b32 v103, 16, v103
    v_sub_f32 v100, v100, v48
    v_sub_f32 v101, v101, v48
    v_sub_f32 v102, v102, v49
    v_sub_f32 v103, v103, v49
    v_cvt_pk_bf16_f32 v52, v100, v101
    v_cvt_pk_bf16_f32 v53, v102, v103
    v_lshlrev_b32 v100, 16, v52
    v_and_b32 v101, 0xffff0000, v52
    v_lshlrev_b32 v102, 16, v53
    v_and_b32 v103, 0xffff0000, v53
    v_mul_f32 v100, v100, v50
    v_mul_f32 v101, v101, v50
    v_mul_f32 v102, v102, v51
    v_mul_f32 v103, v103, v51
    v_cvt_pk_bf16_f32 v52, v100, v101
    v_cvt_pk_bf16_f32 v53, v102, v103
    v_lshlrev_b32 v100, 16, v52
    v_and_b32 v101, 0xffff0000, v52
    v_lshlrev_b32 v102, 16, v53
    v_and_b32 v103, 0xffff0000, v53
    s_mul_i32 s60, s31, 112
    s_add_u32 s60, s60, 0
    v_add_u32 v10, s60, v0
    v_lshrrev_b32 v8, 2, v10
    v_lshrrev_b32 v5, 3, v8
    v_lshlrev_b32 v5, 6, v5
    v_and_b32 v9, 3, v8
    v_lshl_add_u32 v5, v9, 4, v5
    v_bfe_u32 v9, v8, 2, 1
    v_lshl_add_u32 v5, v9, 3, v5
    v_and_b32 v10, 3, v10
    v_lshl_add_u32 v5, v10, 1, v5
    v_add_u32 v5, 131072, v5
    v_mov_b32 v8, 135296
    v_cndmask_b32 v5, v8, v5, s[66:67]
    s_mul_i32 s60, s31, 112
    s_add_u32 s60, s60, 56
    v_add_u32 v10, s60, v0
    v_lshrrev_b32 v8, 2, v10
    v_lshrrev_b32 v6, 3, v8
    v_lshlrev_b32 v6, 6, v6
    v_and_b32 v9, 3, v8
    v_lshl_add_u32 v6, v9, 4, v6
    v_bfe_u32 v9, v8, 2, 1
    v_lshl_add_u32 v6, v9, 3, v6
    v_and_b32 v10, 3, v10
    v_lshl_add_u32 v6, v10, 1, v6
    v_add_u32 v6, 131072, v6
    v_mov_b32 v8, 135296
    v_cndmask_b32 v6, v8, v6, s[66:67]
    v_lshrrev_b32 v2, 2, v0
    v_lshlrev_b32 v1, 7, v2
    v_and_b32 v2, 6, v2
    s_lshl_b32 s60, s31, 1
    v_xor_b32 v2, s60, v2
    v_lshlrev_b32 v2, 4, v2
    v_and_b32 v3, 3, v0
    v_lshl_add_u32 v2, v3, 3, v2
    v_add_u32 v1, v1, v2
    v_and_b32 v2, 1, v0
    v_mul_u32_u24 v3, 2112, v2
    v_lshrrev_b32 v2, 4, v0
    v_lshl_add_u32 v3, v2, 4, v3
    v_add_u32 v3, 131072, v3
    v_lshlrev_b32 v2, 3, v0
    v_cmp_gt_u32 vcc, 16, v0
    s_nop 1
    v_cndmask_b32 v2, v7, v2, vcc
    s_lshl_b32 s65, s37, 9
    s_lshl_b32 s61, s31, 7
    s_add_u32 s65, s65, s61
    s_add_u32 s65, s65, 32768
    s_mul_i32 s88, s31, 1792
    s_add_u32 s88, s88, 589824
    s_add_u32 s89, s88, 7168
    s_add_u32 s90, s88, 14336
    s_add_u32 s91, s88, 21504
    s_waitcnt lgkmcnt(0)
    s_mul_i32 s38, s38, 0x9e3779b1
    s_add_u32 s38, s38, 0x7f4a7c15
    s_waitcnt vmcnt(0)
    buffer_load_dwordx4 v[32:35], v4, s[44:47], s88 offen offset:0 sc1
    buffer_load_dwordx4 v[36:39], v4, s[44:47], s88 offen offset:896 sc1
    buffer_load_dwordx4 v[40:43], v4, s[44:47], s89 offen offset:0 sc1
    buffer_load_dwordx4 v[44:47], v4, s[44:47], s89 offen offset:896 sc1
    buffer_load_dwordx4 v[48:51], v4, s[44:47], s90 offen offset:0 sc1
    buffer_load_dwordx4 v[52:55], v4, s[44:47], s90 offen offset:896 sc1
    buffer_load_dwordx4 v[56:59], v4, s[44:47], s91 offen offset:0 sc1
    buffer_load_dwordx4 v[60:63], v4, s[44:47], s91 offen offset:896 sc1
    s_barrier
    s_waitcnt vmcnt(8)
    s_barrier
    ds_read_b64_tr_b16 v[128:129], v1 offset:0
    ds_read_b64_tr_b16 v[130:131], v1 offset:2048
    ds_read_b64_tr_b16 v[132:133], v1 offset:4096
    ds_read_b64_tr_b16 v[134:135], v1 offset:6144
    ds_read_b64_tr_b16 v[136:137], v1 offset:8192
    ds_read_b64_tr_b16 v[138:139], v1 offset:10240
    ds_read_b64_tr_b16 v[140:141], v1 offset:12288
    ds_read_b64_tr_b16 v[142:143], v1 offset:14336
    s_waitcnt lgkmcnt(4)
    ds_read_b64_tr_b16 v[144:145], v1 offset:16384
    ds_read_b64_tr_b16 v[146:147], v1 offset:18432
    ds_read_b64_tr_b16 v[148:149], v1 offset:20480
    ds_read_b64_tr_b16 v[150:151], v1 offset:22528
    ds_read_b64_tr_b16 v[152:153], v1 offset:24576
    ds_read_b64_tr_b16 v[154:155], v1 offset:26624
    ds_read_b64_tr_b16 v[156:157], v1 offset:28672
    ds_read_b64_tr_b16 v[158:159], v1 offset:30720
    s_waitcnt lgkmcnt(4)
    ds_read_b64_tr_b16 v[160:161], v1 offset:32768
    ds_read_b64_tr_b16 v[162:163], v1 offset:34816
    ds_read_b64_tr_b16 v[164:165], v1 offset:36864
    ds_read_b64_tr_b16 v[166:167], v1 offset:38912
    ds_read_b64_tr_b16 v[168:169], v1 offset:40960
    ds_read_b64_tr_b16 v[170:171], v1 offset:43008
    ds_read_b64_tr_b16 v[172:173], v1 offset:45056
    ds_read_b64_tr_b16 v[174:175], v1 offset:47104
    s_waitcnt lgkmcnt(4)
    ds_read_b64_tr_b16 v[176:177], v1 offset:49152
    ds_read_b64_tr_b16 v[178:179], v1 offset:51200
    ds_read_b64_tr_b16 v[180:181], v1 offset:53248
    ds_read_b64_tr_b16 v[182:183], v1 offset:55296
    s_waitcnt lgkmcnt(0)
    s_branch L_mod0_29
L_mod_30:
    s_sub_u32 s39, s39, 1
    s_cbranch_scc1 L_end
    buffer_load_dwordx4 v[32:35], v4, s[44:47], s88 offen offset:0 sc1
    buffer_load_dwordx4 v[36:39], v4, s[44:47], s88 offen offset:896 sc1
    buffer_load_dwordx4 v[40:43], v4, s[44:47], s89 offen offset:0 sc1
    buffer_load_dwordx4 v[44:47], v4, s[44:47], s89 offen offset:896 sc1
    buffer_load_dwordx4 v[48:51], v4, s[44:47], s90 offen offset:0 sc1
    buffer_load_dwordx4 v[52:55], v4, s[44:47], s90 offen offset:896 sc1
    buffer_load_dwordx4 v[56:59], v4, s[44:47], s91 offen offset:0 sc1
    buffer_load_dwordx4 v[60:63], v4, s[44:47], s91 offen offset:896 sc1
L_mod0_29:
    s_waitcnt vmcnt(0)
    v_min3_u32 v8, v33, v35, v37
    v_min3_u32 v8, v8, v39, v41
    v_min3_u32 v8, v8, v43, v45
    v_min3_u32 v8, v8, v47, v49
    v_min3_u32 v8, v8, v51, v53
    v_min3_u32 v8, v8, v55, v57
    v_min3_u32 v8, v8, v59, v61
    v_min_u32 v8, v8, v63
    v_max3_u32 v9, v33, v35, v37
    v_max3_u32 v9, v9, v39, v41
    v_max3_u32 v9, v9, v43, v45
    v_max3_u32 v9, v9, v47, v49
    v_max3_u32 v9, v9, v51, v53
    v_max3_u32 v9, v9, v55, v57
    v_max3_u32 v9, v9, v59, v61
    v_max_u32 v9, v9, v63
    v_cmp_ne_u32 vcc, s38, v8
    v_cmp_ne_u32 s[68:69], s38, v9
    s_nop 0
    s_or_b64 vcc, vcc, s[68:69]
    s_and_b64 vcc, vcc, s[66:67]
    s_cbranch_vccnz L_mod_30
    v_add_f32 v24, v32, v48
    v_add_f32 v25, v36, v52
    v_add_f32 v26, v34, v50
    v_add_f32 v27, v38, v54
    v_add_f32 v28, v40, v56
    v_add_f32 v29, v44, v60
    v_add_f32 v30, v42, v58
    v_add_f32 v31, v46, v62
    v_cvt_pk_bf16_f32 v8, v24, v25
    v_cvt_pk_bf16_f32 v9, v26, v27
    v_lshlrev_b32 v24, 16, v8
    v_and_b32 v25, 0xffff0000, v8
    v_lshlrev_b32 v26, 16, v9
    v_and_b32 v27, 0xffff0000, v9
    v_cvt_pk_bf16_f32 v10, v28, v29
    v_cvt_pk_bf16_f32 v11, v30, v31
    v_lshlrev_b32 v28, 16, v10
    v_and_b32 v29, 0xffff0000, v10
    v_lshlrev_b32 v30, 16, v11
    v_and_b32 v31, 0xffff0000, v11
    v_add_f32 v28, 1.0, v28
    v_add_f32 v29, 1.0, v29
    v_add_f32 v30, 1.0, v30
    v_add_f32 v31, 1.0, v31
    v_cvt_pk_bf16_f32 v8, v28, v29
    v_cvt_pk_bf16_f32 v9, v30, v31
    v_lshlrev_b32 v28, 16, v8
    v_and_b32 v29, 0xffff0000, v8
    v_lshlrev_b32 v30, 16, v9
    v_and_b32 v31, 0xffff0000, v9
    v_mul_f32 v28, v28, v100
    v_mul_f32 v29, v29, v101
    v_mul_f32 v30, v30, v102
    v_mul_f32 v31, v31, v103
    v_cvt_pk_bf16_f32 v8, v28, v29
    v_cvt_pk_bf16_f32 v9, v30, v31
    v_lshlrev_b32 v28, 16, v8
    v_and_b32 v29, 0xffff0000, v8
    v_lshlrev_b32 v30, 16, v9
    v_and_b32 v31, 0xffff0000, v9
    v_add_f32 v28, v28, v24
    v_add_f32 v29, v29, v25
    v_add_f32 v30, v30, v26
    v_add_f32 v31, v31, v27
    v_cvt_pk_bf16_f32 v8, v28, v29
    v_cvt_pk_bf16_f32 v9, v30, v31
    ds_write_b16 v5, v8
    ds_write_b16_d16_hi v6, v8
    ds_write_b16 v5, v9 offset:2112
    ds_write_b16_d16_hi v6, v9 offset:2112
    s_waitcnt lgkmcnt(0)
    s_barrier
    ds_read_b128 v[32:35], v3 offset:0
    ds_read_b128 v[36:39], v3 offset:64
    ds_read_b128 v[40:43], v3 offset:128
    ds_read_b128 v[44:47], v3 offset:192
    s_waitcnt lgkmcnt(3)
    v_mfma_f32_16x16x32_bf16 v[16:19], v[32:35], v[128:131], 0
    ds_read_b128 v[48:51], v3 offset:256
    s_waitcnt lgkmcnt(3)
    v_mfma_f32_16x16x32_bf16 v[16:19], v[36:39], v[132:135], v[16:19]
    ds_read_b128 v[52:55], v3 offset:320
    s_waitcnt lgkmcnt(3)
    v_mfma_f32_16x16x32_bf16 v[16:19], v[40:43], v[136:139], v[16:19]
    ds_read_b128 v[56:59], v3 offset:384
    s_waitcnt lgkmcnt(3)
    v_mfma_f32_16x16x32_bf16 v[16:19], v[44:47], v[140:143], v[16:19]
    ds_read_b128 v[60:63], v3 offset:448
    s_waitcnt lgkmcnt(3)
    v_mfma_f32_16x16x32_bf16 v[16:19], v[48:51], v[144:147], v[16:19]
    ds_read_b128 v[64:67], v3 offset:512
    s_waitcnt lgkmcnt(3)
    v_mfma_f32_16x16x32_bf16 v[16:19], v[52:55], v[148:151], v[16:19]
    ds_read_b128 v[68:71], v3 offset:576
    s_waitcnt lgkmcnt(3)
    v_mfma_f32_16x16x32_bf16 v[16:19], v[56:59], v[152:155], v[16:19]
    ds_read_b128 v[72:75], v3 offset:640
    s_waitcnt lgkmcnt(3)
    v_mfma_f32_16x16x32_bf16 v[16:19], v[60:63], v[156:159], v[16:19]
    ds_read_b128 v[76:79], v3 offset:704
    s_waitcnt lgkmcnt(3)
    v_mfma_f32_16x16x32_bf16 v[16:19], v[64:67], v[160:163], v[16:19]
    ds_read_b128 v[80:83], v3 offset:768
    s_waitcnt lgkmcnt(3)
    v_mfma_f32_16x16x32_bf16 v[16:19], v[68:71], v[164:167], v[16:19]
    ds_read_b128 v[84:87], v3 offset:832
    s_waitcnt lgkmcnt(3)
    v_mfma_f32_16x16x32_bf16 v[16:19], v[72:75], v[168:171], v[16:19]
    s_waitcnt lgkmcnt(2)
    v_mfma_f32_16x16x32_bf16 v[16:19], v[76:79], v[172:175], v[16:19]
    s_waitcnt lgkmcnt(1)
    v_mfma_f32_16x16x32_bf16 v[16:19], v[80:83], v[176:179], v[16:19]
    s_waitcnt lgkmcnt(0)
    v_mfma_f32_16x16x32_bf16 v[16:19], v[84:87], v[180:183], v[16:19]
    v_mov_b32 v21, s38
    s_nop 6
    v_cvt_pk_bf16_f32 v20, v16, v17
    buffer_store_dwordx2 v[20:21], v2, s[44:47], s65 offen sc1
    s_barrier
    s_branch L_vstream
L_tailxcd:
    s_cmp_lt_u32 s33, 28
    s_cbranch_scc1 L_tail
    s_cmp_lt_u32 s30, 4
    s_cbranch_scc1 L_exit
    s_add_u32 s37, s33, 2
    s_mov_b32 s36, 4
    s_branch L_mjob
L_tail:
    s_mul_i32 s32, s33, 37
    s_lshr_b32 s32, s32, 8
    s_mul_i32 s34, s32, 7
    s_sub_u32 s34, s33, s34
    v_mul_u32_u24 v1, 896, v250
    v_add_u32 v1, v1, v251
    s_mul_i32 s60, s32, 917504
    s_lshl_b32 s61, s34, 7
    s_add_u32 s60, s60, s61
    s_add_u32 s60, s60, 0
    s_mul_i32 s61, s30, 57344
    s_add_u32 s60, s60, s61
    s_lshl_b32 s61, s30, 13
    s_add_u32 s61, s61, 0
    s_waitcnt lgkmcnt(0)
    s_mov_b32 s48, s12
    s_mov_b32 s49, s13
    s_mov_b32 s50, 0x380000
    s_mov_b32 s51, 0x20000
    s_mov_b32 m0, s61
    s_add_u32 s61, s61, 1024
    buffer_load_dwordx4 v1, s[48:51], s60 offen nt lds
    s_add_u32 s60, s60, 7168
    s_mov_b32 m0, s61
    s_add_u32 s61, s61, 1024
    buffer_load_dwordx4 v1, s[48:51], s60 offen nt lds
    s_add_u32 s60, s60, 7168
    s_mov_b32 m0, s61
    s_add_u32 s61, s61, 1024
    buffer_load_dwordx4 v1, s[48:51], s60 offen nt lds
    s_add_u32 s60, s60, 7168
    s_mov_b32 m0, s61
    s_add_u32 s61, s61, 1024
    buffer_load_dwordx4 v1, s[48:51], s60 offen nt lds
    s_add_u32 s60, s60, 7168
    s_mov_b32 m0, s61
    s_add_u32 s61, s61, 1024
    buffer_load_dwordx4 v1, s[48:51], s60 offen nt lds
    s_add_u32 s60, s60, 7168
    s_mov_b32 m0, s61
    s_add_u32 s61, s61, 1024
    buffer_load_dwordx4 v1, s[48:51], s60 offen nt lds
    s_add_u32 s60, s60, 7168
    s_mov_b32 m0, s61
    s_add_u32 s61, s61, 1024
    buffer_load_dwordx4 v1, s[48:51], s60 offen nt lds
    s_add_u32 s60, s60, 7168
    s_mov_b32 m0, s61
    s_nop 0
    buffer_load_dwordx4 v1, s[48:51], s60 offen nt lds
    s_mov_b32 s39, 1000000
    s_mov_b32 s66, -1
    s_mov_b32 s67, 0x00ffffff
    v_mov_b32 v7, 0x40000000
    v_mul_u32_u24 v4, 3584, v250
    v_add_u32 v4, v4, v251
    v_mov_b32 v12, -1
    v_mov_b32 v13, -1
    v_mov_b32 v14, -1
    v_mov_b32 v15, -1
    v_and_b32 v2, 31, v0
    v_lshlrev_b32 v2, 2, v2
    v_add_u32 v2, 138560, v2
    v_mov_b32 v3, 0
    ds_write_b32 v2, v3
    v_lshrrev_b32 v5, 4, v0
    v_and_b32 v8, 15, v0
    v_mul_u32_u24 v64, 1792, v5
    v_lshl_add_u32 v64, v8, 2, v64
    v_cmp_gt_u32 vcc, 32, v0
    s_nop 1
    v_cndmask_b32 v64, v7, v64, vcc
    v_and_b32 v8, 3, v0
    v_cmp_eq_u32 vcc, 0, v8
    s_nop 1
    v_cndmask_b32 v65, v7, v64, vcc
    s_mul_i32 s65, s32, 3584
    s_lshl_b32 s61, s34, 8
    s_add_u32 s65, s65, s61
    s_lshl_b32 s61, s31, 6
    s_add_u32 s65, s65, s61
    s_add_u32 s65, s65, 393216
    s_cmp_lt_u32 s30, 4
    s_cbranch_scc1 L_t_31
    v_lshlrev_b32 v64, 4, v0
    v_mov_b32 v65, v64
    s_lshl2_add_u32 s65, s33, s31
    s_lshl_b32 s65, s65, 10
    s_add_u32 s65, s65, 458752
L_t_31:
    v_add_u32 v64, s65, v64
    v_add_u32 v65, s65, v65
    s_waitcnt lgkmcnt(0)
    s_load_dword s38, s[28:29], 0
    s_mov_b32 s44, s28
    s_mov_b32 s45, s29
    s_mov_b32 s46, 0x100000
    s_mov_b32 s47, 0x20000
    s_mov_b32 s52, s16
    s_mov_b32 s53, s17
    s_mov_b32 s54, 0x188000
    s_mov_b32 s55, 0x20000
    s_mov_b32 s56, s18
    s_mov_b32 s57, s19
    s_mov_b32 s58, 0x188000
    s_mov_b32 s59, 0x20000
    s_mov_b32 s40, s20
    s_mov_b32 s41, s21
    s_mov_b32 s42, 0x188000
    s_mov_b32 s43, 0x20000
    s_cmp_lt_u32 s30, 4
    s_cselect_b32 s60, 0, 0x40000000
    buffer_store_dwordx4 v[12:15], v65, s[44:47], s60 offen sc1
    s_mul_i32 s60, s32, 917504
    s_lshl_b32 s61, s34, 7
    s_add_u32 s60, s60, s61
    s_add_u32 s60, s60, 458752
    s_mul_i32 s61, s30, 57344
    s_add_u32 s60, s60, s61
    s_lshl_b32 s61, s30, 13
    s_add_u32 s61, s61, 65536
    s_mov_b32 m0, s61
    s_add_u32 s61, s61, 1024
    buffer_load_dwordx4 v1, s[48:51], s60 offen nt lds
    s_add_u32 s60, s60, 7168
    s_mov_b32 m0, s61
    s_add_u32 s61, s61, 1024
    buffer_load_dwordx4 v1, s[48:51], s60 offen nt lds
    s_add_u32 s60, s60, 7168
    s_mov_b32 m0, s61
    s_add_u32 s61, s61, 1024
    buffer_load_dwordx4 v1, s[48:51], s60 offen nt lds
    s_add_u32 s60, s60, 7168
    s_mov_b32 m0, s61
    s_add_u32 s61, s61, 1024
    buffer_load_dwordx4 v1, s[48:51], s60 offen nt lds
    s_add_u32 s60, s60, 7168
    s_mov_b32 m0, s61
    s_add_u32 s61, s61, 1024
    buffer_load_dwordx4 v1, s[48:51], s60 offen nt lds
    s_add_u32 s60, s60, 7168
    s_mov_b32 m0, s61
    s_add_u32 s61, s61, 1024
    buffer_load_dwordx4 v1, s[48:51], s60 offen nt lds
    s_add_u32 s60, s60, 7168
    s_mov_b32 m0, s61
    s_add_u32 s61, s61, 1024
    buffer_load_dwordx4 v1, s[48:51], s60 offen nt lds
    s_add_u32 s60, s60, 7168
    s_mov_b32 m0, s61
    s_nop 0
    buffer_load_dwordx4 v1, s[48:51], s60 offen nt lds
    v_lshrrev_b32 v3, 2, v0
    v_lshlrev_b32 v2, 7, v3
    v_and_b32 v3, 6, v3
    s_lshl_b32 s60, s31, 1
    v_xor_b32 v3, s60, v3
    v_lshlrev_b32 v3, 4, v3
    v_and_b32 v5, 3, v0
    v_lshl_add_u32 v3, v5, 3, v3
    v_add_u32 v2, v2, v3
    v_add_u32 v3, 65536, v2
    s_waitcnt lgkmcnt(0)
    s_mul_i32 s38, s38, 0x9e3779b1
    s_add_u32 s38, s38, 0x7f4a7c15
    s_waitcnt vmcnt(8)
    s_barrier
    s_cmp_lt_u32 s30, 4
    s_cbranch_scc0 L_c_32
    ds_read_b64_tr_b16 v[128:129], v2 offset:0
    ds_read_b64_tr_b16 v[130:131], v2 offset:2048
    ds_read_b64_tr_b16 v[132:133], v2 offset:4096
    ds_read_b64_tr_b16 v[134:135], v2 offset:6144
    ds_read_b64_tr_b16 v[136:137], v2 offset:8192
    ds_read_b64_tr_b16 v[138:139], v2 offset:10240
    ds_read_b64_tr_b16 v[140:141], v2 offset:12288
    ds_read_b64_tr_b16 v[142:143], v2 offset:14336
    s_waitcnt lgkmcnt(4)
    ds_read_b64_tr_b16 v[144:145], v2 offset:16384
    ds_read_b64_tr_b16 v[146:147], v2 offset:18432
    ds_read_b64_tr_b16 v[148:149], v2 offset:20480
    ds_read_b64_tr_b16 v[150:151], v2 offset:22528
    ds_read_b64_tr_b16 v[152:153], v2 offset:24576
    ds_read_b64_tr_b16 v[154:155], v2 offset:26624
    ds_read_b64_tr_b16 v[156:157], v2 offset:28672
    ds_read_b64_tr_b16 v[158:159], v2 offset:30720
    s_waitcnt lgkmcnt(4)
    ds_read_b64_tr_b16 v[160:161], v2 offset:32768
    ds_read_b64_tr_b16 v[162:163], v2 offset:34816
    ds_read_b64_tr_b16 v[164:165], v2 offset:36864
    ds_read_b64_tr_b16 v[166:167], v2 offset:38912
    ds_read_b64_tr_b16 v[168:169], v2 offset:40960
    ds_read_b64_tr_b16 v[170:171], v2 offset:43008
    ds_read_b64_tr_b16 v[172:173], v2 offset:45056
    ds_read_b64_tr_b16 v[174:175], v2 offset:47104
    s_waitcnt lgkmcnt(4)
    ds_read_b64_tr_b16 v[176:177], v2 offset:49152
    ds_read_b64_tr_b16 v[178:179], v2 offset:51200
    ds_read_b64_tr_b16 v[180:181], v2 offset:53248
    ds_read_b64_tr_b16 v[182:183], v2 offset:55296
    ds_read_b64_tr_b16 v[184:185], v2 offset:57344
    ds_read_b64_tr_b16 v[186:187], v2 offset:59392
    ds_read_b64_tr_b16 v[188:189], v2 offset:61440
    ds_read_b64_tr_b16 v[190:191], v2 offset:63488
    s_waitcnt lgkmcnt(4)
    s_waitcnt lgkmcnt(0)
L_c_32:
    s_barrier
    s_getreg_b32 s36, hwreg(HW_REG_XCC_ID, 0, 4)
    v_mov_b32 v9, s38
    v_mov_b32 v8, s36
    v_cmp_eq_u32 vcc, 0, v0
    s_nop 1
    v_cndmask_b32 v10, v7, v0, vcc
    s_lshl_b32 s60, s33, 3
    s_add_u32 s60, s60, 2048
    s_cmp_eq_u32 s30, 0
    s_cselect_b32 s60, s60, 0x40000000
    buffer_store_dwordx2 v[8:9], v10, s[44:47], s60 offen sc1
    s_lshl_b32 s60, s33, 7
    s_mul_i32 s61, s30, 200704
    s_add_u32 s60, s60, s61
    s_mul_i32 s61, s30, 7168
    s_mov_b32 m0, s61
    s_add_u32 s61, s61, 1024
    buffer_load_dwordx4 v4, s[52:55], s60 offen nt lds
    s_add_u32 s60, s60, 28672
    s_mov_b32 m0, s61
    s_add_u32 s61, s61, 1024
    buffer_load_dwordx4 v4, s[52:55], s60 offen nt lds
    s_add_u32 s60, s60, 28672
    s_mov_b32 m0, s61
    s_add_u32 s61, s61, 1024
    buffer_load_dwordx4 v4, s[52:55], s60 offen nt lds
    s_add_u32 s60, s60, 28672
    s_mov_b32 m0, s61
    s_add_u32 s61, s61, 1024
    buffer_load_dwordx4 v4, s[52:55], s60 offen nt lds
    s_add_u32 s60, s60, 28672
    s_mov_b32 m0, s61
    s_add_u32 s61, s61, 1024
    buffer_load_dwordx4 v4, s[52:55], s60 offen nt lds
    s_add_u32 s60, s60, 28672
    s_mov_b32 m0, s61
    s_add_u32 s61, s61, 1024
    buffer_load_dwordx4 v4, s[52:55], s60 offen nt lds
    s_add_u32 s60, s60, 28672
    s_mov_b32 m0, s61
    s_nop 0
    buffer_load_dwordx4 v4, s[52:55], s60 offen nt lds
    s_waitcnt vmcnt(7)
    s_barrier
    s_cmp_lt_u32 s30, 4
    s_cbranch_scc0 L_c_33
    ds_read_b64_tr_b16 v[192:193], v3 offset:0
    ds_read_b64_tr_b16 v[194:195], v3 offset:2048
    ds_read_b64_tr_b16 v[196:197], v3 offset:4096
    ds_read_b64_tr_b16 v[198:199], v3 offset:6144
    ds_read_b64_tr_b16 v[200:201], v3 offset:8192
    ds_read_b64_tr_b16 v[202:203], v3 offset:10240
    ds_read_b64_tr_b16 v[204:205], v3 offset:12288
    ds_read_b64_tr_b16 v[206:207], v3 offset:14336
    s_waitcnt lgkmcnt(4)
    ds_read_b64_tr_b16 v[208:209], v3 offset:16384
    ds_read_b64_tr_b16 v[210:211], v3 offset:18432
    ds_read_b64_tr_b16 v[212:213], v3 offset:20480
    ds_read_b64_tr_b16 v[214:215], v3 offset:22528
    ds_read_b64_tr_b16 v[216:217], v3 offset:24576
    ds_read_b64_tr_b16 v[218:219], v3 offset:26624
    ds_read_b64_tr_b16 v[220:221], v3 offset:28672
    ds_read_b64_tr_b16 v[222:223], v3 offset:30720
    s_waitcnt lgkmcnt(4)
    ds_read_b64_tr_b16 v[224:225], v3 offset:32768
    ds_read_b64_tr_b16 v[226:227], v3 offset:34816
    ds_read_b64_tr_b16 v[228:229], v3 offset:36864
    ds_read_b64_tr_b16 v[230:231], v3 offset:38912
    ds_read_b64_tr_b16 v[232:233], v3 offset:40960
    ds_read_b64_tr_b16 v[234:235], v3 offset:43008
    ds_read_b64_tr_b16 v[236:237], v3 offset:45056
    ds_read_b64_tr_b16 v[238:239], v3 offset:47104
    s_waitcnt lgkmcnt(4)
    ds_read_b64_tr_b16 v[240:241], v3 offset:49152
    ds_read_b64_tr_b16 v[242:243], v3 offset:51200
    ds_read_b64_tr_b16 v[244:245], v3 offset:53248
    ds_read_b64_tr_b16 v[246:247], v3 offset:55296
    ds_read_b64_tr_b16 v[248:249], v3 offset:57344
    ds_read_b64_tr_b16 v[250:251], v3 offset:59392
    ds_read_b64_tr_b16 v[252:253], v3 offset:61440
    ds_read_b64_tr_b16 v[254:255], v3 offset:63488
    s_waitcnt lgkmcnt(4)
    s_waitcnt lgkmcnt(0)
L_c_33:
    s_barrier
    s_and_b32 s62, s33, 3
    s_mul_i32 s62, s62, 152
    s_mul_i32 s63, s30, 19
    s_add_u32 s62, s62, s63
    v_add_u32 v8, s62, v0
    v_cmp_gt_u32 vcc, 19, v0
    s_nop 1
    v_cndmask_b32 v8, v7, v8, vcc
    v_cmp_gt_u32 vcc, 448, v8
    v_lshlrev_b32 v8, 7, v8
    s_nop 0
    v_cndmask_b32 v8, v7, v8, vcc
    s_or_b32 s62, s33, 3
    s_mul_i32 s62, s62, 57344
    buffer_load_dword v46, v8, s[40:43], s62 offen
    s_lshl_b32 s60, s33, 7
    s_mul_i32 s61, s30, 200704
    s_add_u32 s60, s60, s61
    s_mul_i32 s61, s30, 7168
    s_add_u32 s61, s61, 65536
    s_mov_b32 m0, s61
    s_add_u32 s61, s61, 1024
    buffer_load_dwordx4 v4, s[56:59], s60 offen nt lds
    s_add_u32 s60, s60, 28672
    s_mov_b32 m0, s61
    s_add_u32 s61, s61, 1024
    buffer_load_dwordx4 v4, s[56:59], s60 offen nt lds
    s_add_u32 s60, s60, 28672
    s_mov_b32 m0, s61
    s_add_u32 s61, s61, 1024
    buffer_load_dwordx4 v4, s[56:59], s60 offen nt lds
    s_add_u32 s60, s60, 28672
    s_mov_b32 m0, s61
    s_add_u32 s61, s61, 1024
    buffer_load_dwordx4 v4, s[56:59], s60 offen nt lds
    s_add_u32 s60, s60, 28672
    s_mov_b32 m0, s61
    s_add_u32 s61, s61, 1024
    buffer_load_dwordx4 v4, s[56:59], s60 offen nt lds
    s_add_u32 s60, s60, 28672
    s_mov_b32 m0, s61
    s_add_u32 s61, s61, 1024
    buffer_load_dwordx4 v4, s[56:59], s60 offen nt lds
    s_add_u32 s60, s60, 28672
    s_mov_b32 m0, s61
    s_nop 0
    buffer_load_dwordx4 v4, s[56:59], s60 offen nt lds
    s_waitcnt vmcnt(7)
    s_barrier
    s_cmp_lt_u32 s30, 4
    s_cbranch_scc1 L_c_34
    ds_read_b64_tr_b16 v[88:89], v2 offset:0
    ds_read_b64_tr_b16 v[90:91], v2 offset:2048
    ds_read_b64_tr_b16 v[92:93], v2 offset:4096
    ds_read_b64_tr_b16 v[94:95], v2 offset:6144
    ds_read_b64_tr_b16 v[96:97], v2 offset:8192
    ds_read_b64_tr_b16 v[98:99], v2 offset:10240
    ds_read_b64_tr_b16 v[100:101], v2 offset:12288
    ds_read_b64_tr_b16 v[102:103], v2 offset:14336
    s_waitcnt lgkmcnt(4)
    ds_read_b64_tr_b16 v[104:105], v2 offset:16384
    ds_read_b64_tr_b16 v[106:107], v2 offset:18432
    ds_read_b64_tr_b16 v[108:109], v2 offset:20480
    ds_read_b64_tr_b16 v[110:111], v2 offset:22528
    ds_read_b64_tr_b16 v[112:113], v2 offset:24576
    ds_read_b64_tr_b16 v[114:115], v2 offset:26624
    ds_read_b64_tr_b16 v[116:117], v2 offset:28672
    ds_read_b64_tr_b16 v[118:119], v2 offset:30720
    s_waitcnt lgkmcnt(4)
    ds_read_b64_tr_b16 v[120:121], v2 offset:32768
    ds_read_b64_tr_b16 v[122:123], v2 offset:34816
    ds_read_b64_tr_b16 v[124:125], v2 offset:36864
    ds_read_b64_tr_b16 v[126:127], v2 offset:38912
    ds_read_b64_tr_b16 v[128:129], v2 offset:40960
    ds_read_b64_tr_b16 v[130:131], v2 offset:43008
    ds_read_b64_tr_b16 v[132:133], v2 offset:45056
    ds_read_b64_tr_b16 v[134:135], v2 offset:47104
    s_waitcnt lgkmcnt(4)
    ds_read_b64_tr_b16 v[136:137], v2 offset:49152
    ds_read_b64_tr_b16 v[138:139], v2 offset:51200
    ds_read_b64_tr_b16 v[140:141], v2 offset:53248
    ds_read_b64_tr_b16 v[142:143], v2 offset:55296
    s_waitcnt lgkmcnt(0)
L_c_34:
    s_barrier
    s_lshr_b32 s96, s31, 1
    s_and_b32 s97, s31, 1
    s_lshr_b32 s35, s30, 2
    s_lshl1_add_u32 s37, s32, s35
    v_lshrrev_b32 v4, 4, v0
    v_and_b32 v5, 15, v0
    v_mov_b32 v87, v7
    s_mov_b32 s100, 0
    v_and_b32 v8, 1, v0
    v_mul_u32_u24 v6, 0xaaaa, v8
    v_add_u32 v6, 0x4444, v6
    buffer_load_dword v47, v64, s[44:47], 0 offen sc1
    s_cmp_lt_u32 s30, 4
    s_cbranch_scc1 L_oprep
    v_lshlrev_b32 v9, 4, v0
    v_cndmask_b32 v9, v7, v9, s[66:67]
    s_mul_i32 s88, s31, 896
    s_add_u32 s88, s88, 11264
    s_add_u32 s89, s88, 3584
    s_add_u32 s90, s89, 3584
    s_mul_i32 s3, s31, 28
    s_add_u32 s3, s3, s33
    s_lshr_b32 s60, s3, 3
    s_mul_i32 s60, s60, 112
    s_and_b32 s61, s3, 1
    s_lshl3_add_u32 s60, s61, s60
    s_bfe_u32 s61, s3, 0x10002
    s_lshl_b32 s61, s61, 1
    s_bfe_u32 s62, s3, 0x10001
    v_and_b32 v10, 1, v4
    v_lshlrev_b32 v10, 2, v10
    v_lshrrev_b32 v11, 5, v0
    v_add3_u32 v10, v10, v11, s61
    v_and_b32 v11, 7, v0
    v_lshl_add_u32 v11, v10, 4, v11
    v_add_u32 v11, s60, v11
    v_cmp_gt_u32 vcc, 7, v10
    s_nop 1
    v_cndmask_b32 v11, 0, v11, vcc
    v_min_u32 v11, 447, v11
    s_mul_i32 s60, s62, 448
    v_add_u32 v67, s60, v11
    v_lshlrev_b32 v87, 1, v67
    v_cndmask_b32 v87, v7, v87, vcc
    v_and_b32 v10, 8, v0
    v_cmp_eq_u32 vcc, 0, v10
    s_nop 1
    v_cndmask_b32 v87, v7, v87, vcc
    v_lshlrev_b32 v67, 2, v67
    v_add_u32 v67, 139584, v67
    v_lshlrev_b32 v10, 3, v11
    s_mov_b32 s91, 22016
    s_lshl_b32 s92, s62, 4
    s_sub_u32 s92, 16, s92
    s_mov_b32 s48, s4
    s_mov_b32 s49, s5
    s_mov_b32 s50, 0x700
    s_mov_b32 s51, 0x20000
    s_mov_b32 s52, s26
    s_mov_b32 s53, s27
    s_mov_b32 s54, 0x700
    s_mov_b32 s55, 0x20000
    v_lshlrev_b32 v11, 3, v0
    v_cndmask_b32 v11, v7, v11, s[66:67]
    s_mul_i32 s60, s31, 448
    buffer_load_dwordx2 v[44:45], v11, s[48:51], s60 offen
    buffer_load_dword v46, v11, s[52:55], 0 offen
    s_mul_i32 s61, s97, 56
    v_add_u32 v11, s61, v0
    v_lshrrev_b32 v68, 4, v11
    v_mul_u32_u24 v68, 576, v68
    v_bfe_u32 v8, v11, 3, 1
    v_lshl_add_u32 v68, v8, 5, v68
    v_and_b32 v8, 3, v11
    v_lshl_add_u32 v68, v8, 3, v68
    v_bfe_u32 v8, v11, 2, 1
    v_lshl_add_u32 v68, v8, 2, v68
    s_lshl_b32 s61, s96, 7
    s_add_u32 s61, s61, 143168
    v_add_u32 v68, s61, v68
    v_mov_b32 v15, 139072
    v_cndmask_b32 v68, v15, v68, s[66:67]
    v_and_b32 v8, 1, v0
    v_lshlrev_b32 v69, 6, v8
    v_bfe_u32 v8, v0, 2, 1
    v_lshl_add_u32 v69, v8, 7, v69
    v_bfe_u32 v8, v0, 1, 1
    v_mul_u32_u24 v8, 288, v8
    v_add_u32 v69, v8, v69
    v_lshl_add_u32 v69, v4, 4, v69
    v_add_u32 v69, 143168, v69
    s_mul_i32 s61, s31, 28
    v_lshrrev_b32 v11, 1, v0
    v_add_u32 v11, s61, v11
    v_lshrrev_b32 v12, 4, v11
    v_mul_u32_u24 v12, 576, v12
    v_bfe_u32 v8, v11, 3, 1
    v_lshl_add_u32 v12, v8, 5, v12
    v_and_b32 v8, 3, v11
    v_lshl_add_u32 v12, v8, 3, v12
    v_bfe_u32 v8, v11, 2, 1
    v_lshl_add_u32 v12, v8, 2, v12
    v_and_b32 v8, 1, v0
    v_lshl_add_u32 v12, v8, 6, v12
    v_add_u32 v12, 143168, v12
    v_cndmask_b32 v12, v15, v12, s[66:67]
    s_mul_i32 s61, s31, 224
    s_add_u32 s61, s61, 147264
    v_lshl_add_u32 v13, v0, 2, s61
    v_mov_b32 v8, 149312
    v_cndmask_b32 v13, v8, v13, s[66:67]
    s_mul_i32 s61, s31, 448
    s_add_u32 s61, s61, 147264
    v_lshl_add_u32 v14, v0, 3, s61
    s_mov_b32 s62, 0x05040100
    s_mov_b32 s63, 0x07060302
    buffer_load_dwordx4 v[16:19], v9, s[44:47], s88 offen sc1
    buffer_load_dwordx4 v[20:23], v9, s[44:47], s89 offen sc1
    buffer_load_dwordx4 v[24:27], v9, s[44:47], s90 offen sc1
    s_waitcnt vmcnt(5)
    s_barrier
    ds_read_b64_tr_b16 v[144:145], v3 offset:0
    ds_read_b64_tr_b16 v[146:147], v3 offset:2048
    ds_read_b64_tr_b16 v[148:149], v3 offset:4096
    ds_read_b64_tr_b16 v[150:151], v3 offset:6144
    ds_read_b64_tr_b16 v[152:153], v3 offset:8192
    ds_read_b64_tr_b16 v[154:155], v3 offset:10240
    ds_read_b64_tr_b16 v[156:157], v3 offset:12288
    ds_read_b64_tr_b16 v[158:159], v3 offset:14336
    s_waitcnt lgkmcnt(4)
    ds_read_b64_tr_b16 v[160:161], v3 offset:16384
    ds_read_b64_tr_b16 v[162:163], v3 offset:18432
    ds_read_b64_tr_b16 v[164:165], v3 offset:20480
    ds_read_b64_tr_b16 v[166:167], v3 offset:22528
    ds_read_b64_tr_b16 v[168:169], v3 offset:24576
    ds_read_b64_tr_b16 v[170:171], v3 offset:26624
    ds_read_b64_tr_b16 v[172:173], v3 offset:28672
    ds_read_b64_tr_b16 v[174:175], v3 offset:30720
    s_waitcnt lgkmcnt(4)
    ds_read_b64_tr_b16 v[176:177], v3 offset:32768
    ds_read_b64_tr_b16 v[178:179], v3 offset:34816
    ds_read_b64_tr_b16 v[180:181], v3 offset:36864
    ds_read_b64_tr_b16 v[182:183], v3 offset:38912
    ds_read_b64_tr_b16 v[184:185], v3 offset:40960
    ds_read_b64_tr_b16 v[186:187], v3 offset:43008
    ds_read_b64_tr_b16 v[188:189], v3 offset:45056
    ds_read_b64_tr_b16 v[190:191], v3 offset:47104
    s_waitcnt lgkmcnt(4)
    ds_read_b64_tr_b16 v[192:193], v3 offset:49152
    ds_read_b64_tr_b16 v[194:195], v3 offset:51200
    ds_read_b64_tr_b16 v[196:197], v3 offset:53248
    ds_read_b64_tr_b16 v[198:199], v3 offset:55296
    s_waitcnt lgkmcnt(0)
    s_branch L_m2_35
L_mod2_36:
    s_sub_u32 s39, s39, 1
    s_cbranch_scc1 L_end
    buffer_load_dwordx4 v[16:19], v9, s[44:47], s88 offen sc1
    buffer_load_dwordx4 v[20:23], v9, s[44:47], s89 offen sc1
    buffer_load_dwordx4 v[24:27], v9, s[44:47], s90 offen sc1
L_m2_35:
    s_waitcnt vmcnt(0)
    v_min3_u32 v8, v17, v19, v21
    v_min3_u32 v8, v8, v23, v25
    v_min_u32 v8, v8, v27
    v_max3_u32 v11, v17, v19, v21
    v_max3_u32 v11, v11, v23, v25
    v_max_u32 v11, v11, v27
    v_cmp_ne_u32 vcc, s38, v8
    v_cmp_ne_u32 s[68:69], s38, v11
    s_nop 0
    s_or_b64 vcc, vcc, s[68:69]
    s_and_b64 vcc, vcc, s[66:67]
    s_cbranch_vccnz L_mod2_36
    v_perm_b32 v32, v18, v16, s62
    v_perm_b32 v33, v18, v16, s63
    v_perm_b32 v34, v22, v20, s62
    v_perm_b32 v35, v22, v20, s63
    v_lshlrev_b32 v36, 16, v24
    v_and_b32 v38, 0xffff0000, v24
    v_lshlrev_b32 v37, 16, v26
    v_and_b32 v39, 0xffff0000, v26
    v_add_f32 v36, 1.0, v36
    v_add_f32 v37, 1.0, v37
    v_add_f32 v38, 1.0, v38
    v_add_f32 v39, 1.0, v39
    v_cvt_pk_bf16_f32 v36, v36, v37
    v_cvt_pk_bf16_f32 v37, v38, v39
    ds_write2_b32 v13, v32, v33 offset0:0 offset1:224
    ds_write2_b32 v12, v34, v35 offset0:72 offset1:104
    ds_write2_b32 v12, v36, v37 offset0:0 offset1:32
    v_lshlrev_b32 v78, 16, v44
    v_and_b32 v79, 0xffff0000, v44
    v_lshlrev_b32 v80, 16, v45
    v_and_b32 v81, 0xffff0000, v45
    s_waitcnt lgkmcnt(0)
    s_barrier
    ds_read_b64 v[60:61], v14
    ds_read2_b32 v[62:63], v68 offset0:0 offset1:16
    ds_read_b128 v[32:35], v69 offset:0
    ds_read_b128 v[36:39], v69 offset:576
    ds_read_b128 v[40:43], v69 offset:1152
    ds_read_b128 v[44:47], v69 offset:1728
    ds_read_b128 v[48:51], v69 offset:2304
    ds_read_b128 v[52:55], v69 offset:2880
    ds_read_b128 v[56:59], v69 offset:3456
    v_mov_b32 v200, 0
    v_mov_b32 v201, 0
    v_mov_b32 v202, 0
    v_mov_b32 v203, 0
    v_mov_b32 v204, 0
    v_mov_b32 v205, 0
    v_mov_b32 v206, 0
    v_mov_b32 v207, 0
    s_waitcnt lgkmcnt(0)
    v_smfmac_f32_16x16x64_bf16 v[200:203], v[32:35], v[88:95], v6
    v_smfmac_f32_16x16x64_bf16 v[204:207], v[32:35], v[144:151], v6
    v_smfmac_f32_16x16x64_bf16 v[200:203], v[36:39], v[96:103], v6
    v_smfmac_f32_16x16x64_bf16 v[204:207], v[36:39], v[152:159], v6
    v_smfmac_f32_16x16x64_bf16 v[200:203], v[40:43], v[104:111], v6
    v_smfmac_f32_16x16x64_bf16 v[204:207], v[40:43], v[160:167], v6
    v_smfmac_f32_16x16x64_bf16 v[200:203], v[44:47], v[112:119], v6
    v_smfmac_f32_16x16x64_bf16 v[204:207], v[44:47], v[168:175], v6
    v_smfmac_f32_16x16x64_bf16 v[200:203], v[48:51], v[120:127], v6
    v_smfmac_f32_16x16x64_bf16 v[204:207], v[48:51], v[176:183], v6
    v_smfmac_f32_16x16x64_bf16 v[200:203], v[52:55], v[128:135], v6
    v_smfmac_f32_16x16x64_bf16 v[204:207], v[52:55], v[184:191], v6
    v_smfmac_f32_16x16x64_bf16 v[200:203], v[56:59], v[136:143], v6
    v_smfmac_f32_16x16x64_bf16 v[204:207], v[56:59], v[192:199], v6
    v_cndmask_b32 v60, 0, v60, s[66:67]
    v_cndmask_b32 v61, 0, v61, s[66:67]
    v_cndmask_b32 v62, 0, v62, s[66:67]
    v_cndmask_b32 v63, 0, v63, s[66:67]
    v_lshlrev_b32 v70, 16, v60
    v_and_b32 v71, 0xffff0000, v60
    v_lshlrev_b32 v72, 16, v61
    v_and_b32 v73, 0xffff0000, v61
    v_lshlrev_b32 v74, 16, v62
    v_and_b32 v75, 0xffff0000, v62
    v_lshlrev_b32 v76, 16, v63
    v_and_b32 v77, 0xffff0000, v63
    v_add_f32 v82, v200, v201
    v_add_f32 v83, v202, v203
    v_add_f32 v84, v204, v205
    v_add_f32 v85, v206, v207
    v_lshrrev_b32 v2, 2, v0
    v_mul_u32_u24 v9, 896, v2
    v_and_b32 v8, 3, v0
    v_lshl_add_u32 v9, v8, 3, v9
    v_bfe_u32 v2, v0, 3, 2
    s_mul_i32 s60, s31, 7
    s_add_u32 s61, s60, 0
    v_xor_b32 v8, s61, v2
    v_lshl_add_u32 v207, v8, 5, v9
    s_add_u32 s61, s60, 1
    v_xor_b32 v8, s61, v2
    v_lshl_add_u32 v215, v8, 5, v9
    s_add_u32 s61, s60, 2
    v_xor_b32 v8, s61, v2
    v_lshl_add_u32 v223, v8, 5, v9
    s_add_u32 s61, s60, 3
    v_xor_b32 v8, s61, v2
    v_lshl_add_u32 v231, v8, 5, v9
    s_add_u32 s61, s60, 4
    v_xor_b32 v8, s61, v2
    v_lshl_add_u32 v239, v8, 5, v9
    s_add_u32 s61, s60, 5
    v_xor_b32 v8, s61, v2
    v_lshl_add_u32 v247, v8, 5, v9
    s_add_u32 s61, s60, 6
    v_xor_b32 v8, s61, v2
    v_lshl_add_u32 v255, v8, 5, v9
    s_branch L_mlprep
L_oprep:
    v_mov_b32 v68, 0
    v_mov_b32 v69, 0
    v_mov_b32 v70, 0
    v_mov_b32 v71, 0
    s_mul_i32 s60, s33, 57344
    s_mul_i32 s61, s31, 14336
    s_add_u32 s60, s60, s61
    v_lshrrev_b32 v2, 3, v0
    v_add_u32 v1, 0, v2
    v_mul_u32_u24 v1, 147, v1
    v_bfe_u32 v1, v1, 11, 2
    v_lshlrev_b32 v1, 1, v1
    v_xor_b32 v1, v1, v0
    v_lshlrev_b32 v1, 4, v1
    s_mov_b32 m0, s61
    s_add_u32 s61, s61, 1024
    buffer_load_dwordx4 v1, s[40:43], s60 offen nt lds
    s_add_u32 s60, s60, 1024
    v_add_u32 v1, 8, v2
    v_mul_u32_u24 v1, 147, v1
    v_bfe_u32 v1, v1, 11, 2
    v_lshlrev_b32 v1, 1, v1
    v_xor_b32 v1, v1, v0
    v_lshlrev_b32 v1, 4, v1
    s_mov_b32 m0, s61
    s_add_u32 s61, s61, 1024
    buffer_load_dwordx4 v1, s[40:43], s60 offen nt lds
    s_add_u32 s60, s60, 1024
    v_add_u32 v1, 16, v2
    v_mul_u32_u24 v1, 147, v1
    v_bfe_u32 v1, v1, 11, 2
    v_lshlrev_b32 v1, 1, v1
    v_xor_b32 v1, v1, v0
    v_lshlrev_b32 v1, 4, v1
    s_mov_b32 m0, s61
    s_add_u32 s61, s61, 1024
    buffer_load_dwordx4 v1, s[40:43], s60 offen nt lds
    s_add_u32 s60, s60, 1024
    v_add_u32 v1, 24, v2
    v_mul_u32_u24 v1, 147, v1
    v_bfe_u32 v1, v1, 11, 2
    v_lshlrev_b32 v1, 1, v1
    v_xor_b32 v1, v1, v0
    v_lshlrev_b32 v1, 4, v1
    s_mov_b32 m0, s61
    s_add_u32 s61, s61, 1024
    buffer_load_dwordx4 v1, s[40:43], s60 offen nt lds
    s_add_u32 s60, s60, 1024
    v_add_u32 v1, 32, v2
    v_mul_u32_u24 v1, 147, v1
    v_bfe_u32 v1, v1, 11, 2
    v_lshlrev_b32 v1, 1, v1
    v_xor_b32 v1, v1, v0
    v_lshlrev_b32 v1, 4, v1
    s_mov_b32 m0, s61
    s_add_u32 s61, s61, 1024
    buffer_load_dwordx4 v1, s[40:43], s60 offen nt lds
    s_add_u32 s60, s60, 1024
    v_add_u32 v1, 40, v2
    v_mul_u32_u24 v1, 147, v1
    v_bfe_u32 v1, v1, 11, 2
    v_lshlrev_b32 v1, 1, v1
    v_xor_b32 v1, v1, v0
    v_lshlrev_b32 v1, 4, v1
    s_mov_b32 m0, s61
    s_add_u32 s61, s61, 1024
    buffer_load_dwordx4 v1, s[40:43], s60 offen nt lds
    s_add_u32 s60, s60, 1024
    s_waitcnt vmcnt(6)
    s_barrier
    v_add_u32 v1, 48, v2
    v_mul_u32_u24 v1, 147, v1
    v_bfe_u32 v1, v1, 11, 2
    v_lshlrev_b32 v1, 1, v1
    v_xor_b32 v1, v1, v0
    v_lshlrev_b32 v1, 4, v1
    s_mov_b32 m0, s61
    s_add_u32 s61, s61, 1024
    buffer_load_dwordx4 v1, s[40:43], s60 offen nt lds
    s_add_u32 s60, s60, 1024
    v_add_u32 v1, 56, v2
    v_mul_u32_u24 v1, 147, v1
    v_bfe_u32 v1, v1, 11, 2
    v_lshlrev_b32 v1, 1, v1
    v_xor_b32 v1, v1, v0
    v_lshlrev_b32 v1, 4, v1
    s_mov_b32 m0, s61
    s_add_u32 s61, s61, 1024
    buffer_load_dwordx4 v1, s[40:43], s60 offen nt lds
    s_add_u32 s60, s60, 1024
    v_add_u32 v1, 64, v2
    v_mul_u32_u24 v1, 147, v1
    v_bfe_u32 v1, v1, 11, 2
    v_lshlrev_b32 v1, 1, v1
    v_xor_b32 v1, v1, v0
    v_lshlrev_b32 v1, 4, v1
    s_mov_b32 m0, s61
    s_add_u32 s61, s61, 1024
    buffer_load_dwordx4 v1, s[40:43], s60 offen nt lds
    s_add_u32 s60, s60, 1024
    v_add_u32 v1, 72, v2
    v_mul_u32_u24 v1, 147, v1
    v_bfe_u32 v1, v1, 11, 2
    v_lshlrev_b32 v1, 1, v1
    v_xor_b32 v1, v1, v0
    v_lshlrev_b32 v1, 4, v1
    s_mov_b32 m0, s61
    s_add_u32 s61, s61, 1024
    buffer_load_dwordx4 v1, s[40:43], s60 offen nt lds
    s_add_u32 s60, s60, 1024
    v_add_u32 v1, 80, v2
    v_mul_u32_u24 v1, 147, v1
    v_bfe_u32 v1, v1, 11, 2
    v_lshlrev_b32 v1, 1, v1
    v_xor_b32 v1, v1, v0
    v_lshlrev_b32 v1, 4, v1
    s_mov_b32 m0, s61
    s_add_u32 s61, s61, 1024
    buffer_load_dwordx4 v1, s[40:43], s60 offen nt lds
    s_add_u32 s60, s60, 1024
    v_add_u32 v1, 88, v2
    v_mul_u32_u24 v1, 147, v1
    v_bfe_u32 v1, v1, 11, 2
    v_lshlrev_b32 v1, 1, v1
    v_xor_b32 v1, v1, v0
    v_lshlrev_b32 v1, 4, v1
    s_mov_b32 m0, s61
    s_add_u32 s61, s61, 1024
    buffer_load_dwordx4 v1, s[40:43], s60 offen nt lds
    s_add_u32 s60, s60, 1024
    v_add_u32 v1, 96, v2
    v_mul_u32_u24 v1, 147, v1
    v_bfe_u32 v1, v1, 11, 2
    v_lshlrev_b32 v1, 1, v1
    v_xor_b32 v1, v1, v0
    v_lshlrev_b32 v1, 4, v1
    s_mov_b32 m0, s61
    s_add_u32 s61, s61, 1024
    buffer_load_dwordx4 v1, s[40:43], s60 offen nt lds
    s_add_u32 s60, s60, 1024
    v_add_u32 v1, 104, v2
    v_mul_u32_u24 v1, 147, v1
    v_bfe_u32 v1, v1, 11, 2
    v_lshlrev_b32 v1, 1, v1
    v_xor_b32 v1, v1, v0
    v_lshlrev_b32 v1, 4, v1
    s_mov_b32 m0, s61
    s_add_u32 s61, s61, 1024
    buffer_load_dwordx4 v1, s[40:43], s60 offen nt lds
    s_add_u32 s60, s60, 1024
    s_lshl2_add_u32 s60, s33, s31
    s_lshl_b32 s60, s60, 8
    v_lshl_add_u32 v9, v0, 7, s60
    v_min_u32 v9, L_exit-L_pc, v9
    s_mov_b64 exec, 3
    global_load_dword v11, v9, s[98:99]
    s_mov_b64 exec, -1
    v_mov_b32 v10, 0
    s_mov_b32 s91, 2048
    s_mov_b32 s92, 0
    s_barrier
L_mlprep:
    v_lshlrev_b32 v1, 10, v4
    v_lshl_add_u32 v1, v5, 4, v1
    s_lshl_b32 s60, s37, 15
    s_lshl_b32 s61, s96, 14
    s_add_u32 s60, s60, s61
    s_lshl_b32 s61, s97, 9
    s_add_u32 s60, s60, s61
    s_add_u32 s60, s60, 131072
    v_add_u32 v1, s60, v1
    v_lshrrev_b32 v9, 1, v4
    v_lshlrev_b32 v9, 5, v9
    v_lshrrev_b32 v8, 3, v5
    v_lshl_add_u32 v9, v8, 4, v9
    v_and_b32 v8, 3, v5
    v_lshl_add_u32 v9, v8, 2, v9
    v_and_b32 v8, 1, v4
    v_lshl_add_u32 v9, v8, 1, v9
    v_bfe_u32 v8, v5, 2, 1
    v_add_u32 v9, v9, v8
    s_lshl1_add_u32 s61, s35, s97
    s_lshl_b32 s61, s61, 6
    v_add_u32 v9, s61, v9
    v_lshrrev_b32 v2, 4, v9
    v_mul_u32_u24 v2, 256, v2
    v_bfe_u32 v8, v9, 3, 1
    v_lshl_add_u32 v2, v8, 5, v2
    v_and_b32 v8, 3, v9
    v_lshl_add_u32 v2, v8, 3, v2
    v_bfe_u32 v8, v9, 2, 1
    v_lshl_add_u32 v2, v8, 2, v2
    s_lshl_b32 s61, s96, 7
    s_add_u32 s61, s61, 131072
    v_add_u32 v2, s61, v2
    v_and_b32 v8, 1, v0
    v_lshlrev_b32 v3, 6, v8
    v_bfe_u32 v8, v0, 2, 1
    v_lshl_add_u32 v3, v8, 7, v3
    v_lshl_add_u32 v3, v4, 4, v3
    v_add_u32 v65, 138688, v3
    v_add_u32 v3, 131072, v3
    v_mov_b32 v44, 0
    v_mov_b32 v45, 0
    v_mov_b32 v46, 0
    v_mov_b32 v47, 0
    v_mov_b32 v60, 0
    v_mov_b32 v61, 0
    v_mov_b32 v62, 0
    v_mov_b32 v63, 0
    v_and_b32 v66, 3, v0
    v_mul_u32_u24 v66, 0x5555, v66
    s_lshl3_add_u32 s60, s96, s37
    s_lshl_b32 s60, s60, 11
    s_lshl_b32 s61, s97, 6
    s_add_u32 s60, s60, s61
    s_add_u32 s60, s60, 65536
    v_lshrrev_b32 v12, 2, v0
    v_lshlrev_b32 v12, 7, v12
    v_and_b32 v13, 3, v0
    v_lshl_add_u32 v12, v13, 4, v12
    v_cndmask_b32 v12, v7, v12, s[66:67]
    v_lshrrev_b32 v13, 1, v0
    v_min_u32 v13, 27, v13
    v_lshlrev_b32 v13, 3, v13
    s_movk_i32 s61, 0x1000
    s_movk_i32 s64, 0x2000
    s_movk_i32 s65, 0x3000
    s_mov_b32 s62, 0x3db8aa3b
L_ml_37:
    s_sub_u32 s39, s39, 1
    s_cbranch_scc1 L_end
    buffer_load_dwordx4 v[16:19], v12, s[44:47], s60 offen sc1
    buffer_load_dwordx2 v[20:21], v13, s[44:47], 0 offen offset:2048 sc1
    buffer_load_dwordx2 v[24:25], v10, s[44:47], s91 offen sc1
    s_waitcnt vmcnt(0)
    v_min3_u32 v8, v17, v19, v21
    v_min_u32 v8, v8, v25
    v_max3_u32 v9, v17, v19, v21
    v_max_u32 v9, v9, v25
    v_cmp_ne_u32 vcc, s38, v8
    v_cmp_ne_u32 s[68:69], s38, v9
    s_nop 0
    s_or_b64 vcc, vcc, s[68:69]
    s_and_b64 vcc, vcc, s[66:67]
    s_cbranch_vccnz L_ml_37
    v_cmp_ne_u32 vcc, s36, v20
    v_lshlrev_b32 v86, s92, v24
    v_and_b32 v86, 0xffff0000, v86
    s_cmp_eq_u64 vcc, 0
    s_cselect_b32 s36, 1, 0
    s_cmp_lt_u32 s30, 4
    s_cbranch_scc0 L_t_38
    buffer_load_dwordx4 v[32:35], v1, s[44:47], 0 offen offset:0 sc1
    buffer_load_dwordx4 v[48:51], v1, s[44:47], 0 offen offset:256 sc1
    buffer_load_dwordx4 v[36:39], v1, s[44:47], s61 offen offset:0 sc1
    buffer_load_dwordx4 v[52:55], v1, s[44:47], s61 offen offset:256 sc1
    buffer_load_dwordx4 v[40:43], v1, s[44:47], s64 offen offset:0 sc1
    buffer_load_dwordx4 v[56:59], v1, s[44:47], s64 offen offset:256 sc1
    s_mov_b32 exec_hi, 0
    buffer_load_dwordx4 v[44:47], v1, s[44:47], s65 offen offset:0 sc1
    buffer_load_dwordx4 v[60:63], v1, s[44:47], s65 offen offset:256 sc1
    s_mov_b64 exec, -1
L_t_38:
    v_mov_b32 v8, 0xff800000
    v_cndmask_b32 v16, v8, v16, s[66:67]
    s_nop 1
    v_max_f32_dpp v17, v16, v16 quad_perm:[1,0,3,2] row_mask:0xf bank_mask:0xf
    s_nop 1
    v_max_f32_dpp v17, v17, v17 quad_perm:[2,3,0,1] row_mask:0xf bank_mask:0xf
    v_mov_b32 v19, v17
    s_nop 1
    v_max_f32_dpp v19, v19, v19 row_ror:8 row_mask:0xf bank_mask:0xf
    s_nop 1
    v_max_f32_dpp v19, v19, v19 row_ror:4 row_mask:0xf bank_mask:0xf
    s_nop 1
    v_max_f32_dpp v19, v19, v19 row_ror:2 row_mask:0xf bank_mask:0xf
    s_nop 1
    v_max_f32_dpp v19, v19, v19 row_ror:1 row_mask:0xf bank_mask:0xf
    v_mov_b32 v22, v19
    s_nop 1
    v_permlane16_swap_b32 v19, v22
    v_max_f32 v19, v19, v22
    v_mov_b32 v22, v19
    s_nop 1
    v_permlane32_swap_b32 v19, v22
    v_max_f32 v19, v19, v22
    v_sub_f32 v16, v16, v19
    v_sub_f32 v17, v17, v19
    v_mul_f32 v16, s62, v16
    v_mul_f32 v17, s62, v17
    v_exp_f32 v16, v16
    v_exp_f32 v17, v17
    v_mul_f32 v18, v18, v16
    s_nop 1
    v_add_f32_dpp v18, v18, v18 row_ror:8 row_mask:0xf bank_mask:0xf
    s_nop 1
    v_add_f32_dpp v18, v18, v18 row_ror:4 row_mask:0xf bank_mask:0xf
    s_nop 1
    v_add_f32_dpp v18, v18, v18 row_ror:2 row_mask:0xf bank_mask:0xf
    s_nop 1
    v_add_f32_dpp v18, v18, v18 row_ror:1 row_mask:0xf bank_mask:0xf
    v_mov_b32 v22, v18
    s_nop 1
    v_permlane16_swap_b32 v18, v22
    v_add_f32 v18, v18, v22
    v_mov_b32 v22, v18
    s_nop 1
    v_permlane32_swap_b32 v18, v22
    v_add_f32 v18, v18, v22
    v_rcp_f32 v18, v18
    v_lshlrev_b32 v9, 5, v4
    v_mul_f32 v17, v17, v18
    v_cvt_pk_bf16_f32 v8, v17, v17
    v_and_b32 v8, 0xffff0000, v8
    v_sub_f32 v17, v17, v8
    v_cvt_pk_bf16_f32 v8, v8, v17
    ds_bpermute_b32 v12, v9, v8 offset:0
    ds_bpermute_b32 v13, v9, v8 offset:16
    ds_bpermute_b32 v14, v9, v8 offset:128
    ds_bpermute_b32 v15, v9, v8 offset:144
    s_waitcnt lgkmcnt(0)
    s_mov_b32 vcc_lo, 0xf000f
    s_mov_b32 vcc_hi, vcc_lo
    v_cndmask_b32 v16, 0, v12, vcc
    v_cndmask_b32 v18, 0, v13, vcc
    v_cndmask_b32 v20, 0, v14, vcc
    v_cndmask_b32 v22, 0, v15, vcc
    s_mov_b32 vcc_lo, 0xf000f0
    s_mov_b32 vcc_hi, vcc_lo
    v_cndmask_b32 v17, 0, v12, vcc
    v_cndmask_b32 v19, 0, v13, vcc
    v_cndmask_b32 v21, 0, v14, vcc
    v_cndmask_b32 v23, 0, v15, vcc
    s_mov_b32 vcc_lo, 0xf000f00
    s_mov_b32 vcc_hi, vcc_lo
    v_cndmask_b32 v24, 0, v12, vcc
    v_cndmask_b32 v26, 0, v13, vcc
    v_cndmask_b32 v28, 0, v14, vcc
    v_cndmask_b32 v30, 0, v15, vcc
    s_mov_b32 vcc_lo, 0xf000f000
    s_mov_b32 vcc_hi, vcc_lo
    v_cndmask_b32 v25, 0, v12, vcc
    v_cndmask_b32 v27, 0, v13, vcc
    v_cndmask_b32 v29, 0, v14, vcc
    v_cndmask_b32 v31, 0, v15, vcc
    s_cmp_lt_u32 s30, 4
    s_cbranch_scc1 L_t_39
    buffer_load_dwordx4 v[32:35], v1, s[44:47], 0 offen offset:0 sc1
    buffer_load_dwordx4 v[48:51], v1, s[44:47], 0 offen offset:256 sc1
    buffer_load_dwordx4 v[36:39], v1, s[44:47], s61 offen offset:0 sc1
    buffer_load_dwordx4 v[52:55], v1, s[44:47], s61 offen offset:256 sc1
    buffer_load_dwordx4 v[40:43], v1, s[44:47], s64 offen offset:0 sc1
    buffer_load_dwordx4 v[56:59], v1, s[44:47], s64 offen offset:256 sc1
    s_mov_b32 exec_hi, 0
    buffer_load_dwordx4 v[44:47], v1, s[44:47], s65 offen offset:0 sc1
    buffer_load_dwordx4 v[60:63], v1, s[44:47], s65 offen offset:256 sc1
    s_mov_b64 exec, -1
    v_mov_b64 v[8:9], -1
    v_mov_b64 v[10:11], -1
    s_cmp_eq_u32 s36, 1
    s_cbranch_scc0 L_sl_41
    buffer_store_dwordx4 v[8:11], v64, s[44:47], 0 offen
L_sd_42:
    s_barrier
    ds_read_b64_tr_b16 v[200:201], v207 offset:0
    ds_read_b64_tr_b16 v[202:203], v207 offset:14336
    ds_read_b64_tr_b16 v[204:205], v207 offset:28672
    ds_read_b64_tr_b16 v[206:207], v207 offset:43008
    ds_read_b64_tr_b16 v[208:209], v215 offset:0
    ds_read_b64_tr_b16 v[210:211], v215 offset:14336
    ds_read_b64_tr_b16 v[212:213], v215 offset:28672
    ds_read_b64_tr_b16 v[214:215], v215 offset:43008
    s_waitcnt lgkmcnt(4)
    ds_read_b64_tr_b16 v[216:217], v223 offset:0
    ds_read_b64_tr_b16 v[218:219], v223 offset:14336
    ds_read_b64_tr_b16 v[220:221], v223 offset:28672
    ds_read_b64_tr_b16 v[222:223], v223 offset:43008
    ds_read_b64_tr_b16 v[224:225], v231 offset:0
    ds_read_b64_tr_b16 v[226:227], v231 offset:14336
    ds_read_b64_tr_b16 v[228:229], v231 offset:28672
    ds_read_b64_tr_b16 v[230:231], v231 offset:43008
    s_waitcnt lgkmcnt(4)
    ds_read_b64_tr_b16 v[232:233], v239 offset:0
    ds_read_b64_tr_b16 v[234:235], v239 offset:14336
    ds_read_b64_tr_b16 v[236:237], v239 offset:28672
    ds_read_b64_tr_b16 v[238:239], v239 offset:43008
    ds_read_b64_tr_b16 v[240:241], v247 offset:0
    ds_read_b64_tr_b16 v[242:243], v247 offset:14336
    ds_read_b64_tr_b16 v[244:245], v247 offset:28672
    ds_read_b64_tr_b16 v[246:247], v247 offset:43008
    s_waitcnt lgkmcnt(4)
    ds_read_b64_tr_b16 v[248:249], v255 offset:0
    ds_read_b64_tr_b16 v[250:251], v255 offset:14336
    ds_read_b64_tr_b16 v[252:253], v255 offset:28672
    ds_read_b64_tr_b16 v[254:255], v255 offset:43008
    s_branch L_t_40
L_t_39:
    s_barrier
L_t_40:
    s_branch L_h1z_45
L_h1all_44:
    s_mov_b64 s[88:89], -1
    s_mov_b64 s[90:91], -1
    s_mov_b64 s[92:93], -1
    s_mov_b64 s[94:95], -1
    s_mov_b32 s95, 0
    s_mov_b64 exec, s[88:89]
    buffer_load_dwordx4 v[32:35], v1, s[44:47], 0 offen offset:0 sc1
    buffer_load_dwordx4 v[48:51], v1, s[44:47], 0 offen offset:256 sc1
    s_mov_b64 exec, s[90:91]
    buffer_load_dwordx4 v[36:39], v1, s[44:47], s61 offen offset:0 sc1
    buffer_load_dwordx4 v[52:55], v1, s[44:47], s61 offen offset:256 sc1
    s_mov_b64 exec, s[92:93]
    buffer_load_dwordx4 v[40:43], v1, s[44:47], s64 offen offset:0 sc1
    buffer_load_dwordx4 v[56:59], v1, s[44:47], s64 offen offset:256 sc1
    s_mov_b64 exec, s[94:95]
    buffer_load_dwordx4 v[44:47], v1, s[44:47], s65 offen offset:0 sc1
    buffer_load_dwordx4 v[60:63], v1, s[44:47], s65 offen offset:256 sc1
    s_mov_b64 exec, -1
L_h1z_45:
    s_waitcnt vmcnt(0)
    v_mov_b64 v[8:9], 0
    v_mov_b64 v[10:11], 0
    s_branch L_h1w_43
L_h1_46:
    s_sub_u32 s39, s39, 1
    s_cbranch_scc1 L_end
    s_mov_b64 exec, s[88:89]
    buffer_load_dwordx4 v[32:35], v1, s[44:47], 0 offen offset:0 sc1
    buffer_load_dwordx4 v[48:51], v1, s[44:47], 0 offen offset:256 sc1
    s_mov_b64 exec, s[90:91]
    buffer_load_dwordx4 v[36:39], v1, s[44:47], s61 offen offset:0 sc1
    buffer_load_dwordx4 v[52:55], v1, s[44:47], s61 offen offset:256 sc1
    s_mov_b64 exec, s[92:93]
    buffer_load_dwordx4 v[40:43], v1, s[44:47], s64 offen offset:0 sc1
    buffer_load_dwordx4 v[56:59], v1, s[44:47], s64 offen offset:256 sc1
    s_mov_b64 exec, s[94:95]
    buffer_load_dwordx4 v[44:47], v1, s[44:47], s65 offen offset:0 sc1
    buffer_load_dwordx4 v[60:63], v1, s[44:47], s65 offen offset:256 sc1
    s_mov_b64 exec, -1
    s_waitcnt vmcnt(0)
L_h1w_43:
    v_max_u32 v12, v35, v51
    v_max_u32 v13, v39, v55
    v_max_u32 v14, v43, v59
    v_max_u32 v15, v47, v63
    v_cmp_eq_u32 s[88:89], -1, v12
    v_cmp_eq_u32 s[90:91], -1, v13
    v_cmp_eq_u32 s[92:93], -1, v14
    v_cmp_eq_u32 s[94:95], -1, v15
    s_or_b64 vcc, s[88:89], s[90:91]
    s_or_b64 s[68:69], s[92:93], s[94:95]
    s_or_b64 vcc, vcc, s[68:69]
    s_cbranch_scc1 L_h1_46
    v_smfmac_f32_16x16x64_bf16 v[8:11], v[16:19], v[32:39], v66
    v_smfmac_f32_16x16x64_bf16 v[8:11], v[20:23], v[40:47], v66
    v_smfmac_f32_16x16x64_bf16 v[8:11], v[24:27], v[48:55], v66
    v_smfmac_f32_16x16x64_bf16 v[8:11], v[28:31], v[56:63], v66
    s_nop 7
    v_cvt_pk_bf16_f32 v12, v8, v9
    v_cvt_pk_bf16_f32 v13, v10, v11
    v_cmp_u_f32 vcc, v8, v10
    ds_write2_b32 v2, v12, v13 offset0:0 offset1:16
    s_cbranch_vccnz L_h1slow_47
L_h1ok_48:
    s_cmp_ge_u32 s30, 4
    s_waitcnt lgkmcnt(0)
    s_barrier
    s_cbranch_scc1 L_fstage
    ds_read_b128 v[72:75], v3 offset:0
    ds_read_b128 v[76:79], v3 offset:256
    ds_read_b128 v[80:83], v3 offset:512
    ds_read_b128 v[84:87], v3 offset:768
    s_waitcnt lgkmcnt(3)
    v_smfmac_f32_16x16x64_bf16 v[68:71], v[72:75], v[128:135], v6
    ds_read_b128 v[88:91], v3 offset:1024
    s_waitcnt lgkmcnt(3)
    v_smfmac_f32_16x16x64_bf16 v[68:71], v[76:79], v[136:143], v6
    ds_read_b128 v[92:95], v3 offset:1280
    s_waitcnt lgkmcnt(3)
    v_smfmac_f32_16x16x64_bf16 v[68:71], v[80:83], v[144:151], v6
    ds_read_b128 v[96:99], v3 offset:1536
    s_waitcnt lgkmcnt(3)
    v_smfmac_f32_16x16x64_bf16 v[68:71], v[84:87], v[152:159], v6
    ds_read_b128 v[100:103], v3 offset:1792
    s_waitcnt lgkmcnt(3)
    v_smfmac_f32_16x16x64_bf16 v[68:71], v[88:91], v[160:167], v6
    ds_read_b128 v[104:107], v3 offset:2048
    s_waitcnt lgkmcnt(3)
    v_smfmac_f32_16x16x64_bf16 v[68:71], v[92:95], v[168:175], v6
    ds_read_b128 v[108:111], v3 offset:2304
    s_waitcnt lgkmcnt(3)
    v_smfmac_f32_16x16x64_bf16 v[68:71], v[96:99], v[176:183], v6
    ds_read_b128 v[112:115], v3 offset:2560
    s_waitcnt lgkmcnt(3)
    v_smfmac_f32_16x16x64_bf16 v[68:71], v[100:103], v[184:191], v6
    ds_read_b128 v[116:119], v3 offset:2816
    s_waitcnt lgkmcnt(3)
    v_smfmac_f32_16x16x64_bf16 v[68:71], v[104:107], v[192:199], v6
    ds_read_b128 v[120:123], v3 offset:3072
    s_waitcnt lgkmcnt(3)
    v_smfmac_f32_16x16x64_bf16 v[68:71], v[108:111], v[200:207], v6
    ds_read_b128 v[124:127], v3 offset:3328
    s_waitcnt lgkmcnt(3)
    v_smfmac_f32_16x16x64_bf16 v[68:71], v[112:115], v[208:215], v6
    ds_read_b128 v[72:75], v3 offset:3584
    s_waitcnt lgkmcnt(3)
    v_smfmac_f32_16x16x64_bf16 v[68:71], v[116:119], v[216:223], v6
    ds_read_b128 v[76:79], v3 offset:3840
    s_waitcnt lgkmcnt(3)
    v_smfmac_f32_16x16x64_bf16 v[68:71], v[120:123], v[224:231], v6
    s_waitcnt lgkmcnt(2)
    v_smfmac_f32_16x16x64_bf16 v[68:71], v[124:127], v[232:239], v6
    s_waitcnt lgkmcnt(1)
    v_smfmac_f32_16x16x64_bf16 v[68:71], v[72:75], v[240:247], v6
    s_waitcnt lgkmcnt(0)
    v_smfmac_f32_16x16x64_bf16 v[68:71], v[76:79], v[248:255], v6
    s_cmp_eq_u32 s36, 1
    s_nop 6
    v_add_f32 v68, v68, v69
    s_cbranch_scc0 L_sl_49
    buffer_store_dword v68, v64, s[44:47], 0 offen
L_sd_50:
    s_endpgm
L_fstage:
    v_lshlrev_b32 v1, 4, v0
    s_mul_i32 s60, s31, 896
    s_add_u32 s61, s60, 139584
    v_add_u32 v2, s61, v1
    v_mov_b32 v8, 139072
    v_cndmask_b32 v2, v8, v2, s[66:67]
    v_cndmask_b32 v1, v7, v1, s[66:67]
    s_add_u32 s61, s60, 393216
    v_add_u32 v1, s61, v1
    s_movk_i32 s64, 7168
    v_lshrrev_b32 v9, 3, v0
    v_lshlrev_b32 v66, 12, v9
    v_and_b32 v9, 7, v0
    v_lshl_add_u32 v66, v9, 4, v66
    s_min_u32 s61, s3, 31
    s_lshl_b32 s61, s61, 7
    s_add_u32 s61, s61, 458752
    v_add_u32 v66, s61, v66
    s_lshl_b32 s61, s96, 5
    s_lshl2_add_u32 s60, s97, s61
    s_add_u32 s60, s60, 138688
    s_mov_b32 s63, 0x8000
    s_mov_b32 s65, 0x10000
    s_mov_b32 s96, 0x18000
    s_waitcnt vmcnt(0)
    s_lshl_b32 s61, s31, 3
    s_add_u32 s61, s61, 138944
    v_lshrrev_b32 v3, 5, v0
    v_lshl_add_u32 v3, v3, 2, s61
    v_and_b32 v9, 1, v4
    v_cmp_eq_u32 vcc, 1, v9
    s_nop 1
    v_cndmask_b32 v3, v8, v3, vcc
    v_bfe_u32 v9, v0, 3, 1
    v_bfe_u32 v10, v0, 1, 1
    v_lshl_add_u32 v9, v9, 1, v10
    v_mov_b32 v11, 138560
    v_cmp_eq_u32 vcc, 0, v9
    s_nop 1
    v_cndmask_b32 v60, v11, v65, vcc
    v_cmp_eq_u32 vcc, 1, v9
    s_nop 1
    v_cndmask_b32 v61, v11, v65, vcc
    v_cmp_eq_u32 vcc, 2, v9
    s_nop 1
    v_cndmask_b32 v62, v11, v65, vcc
    v_cmp_eq_u32 vcc, 3, v9
    s_nop 1
    v_cndmask_b32 v63, v11, v65, vcc
    v_and_b32 v8, 1, v4
    v_lshlrev_b32 v65, 7, v8
    v_lshl_add_u32 v65, v10, 6, v65
    v_lshrrev_b32 v9, 2, v5
    v_lshl_add_u32 v65, v9, 3, v65
    v_and_b32 v9, 1, v0
    v_lshl_add_u32 v65, v9, 1, v65
    v_add_u32 v65, s60, v65
    v_lshlrev_b32 v5, 4, v8
    v_add_u32 v5, 138944, v5
    v_mov_b32 v52, 0
    v_mov_b32 v53, 0
    v_mov_b32 v54, 0
    v_mov_b32 v55, 0
    v_mov_b32 v56, 0
    v_mov_b32 v57, 0
    v_mov_b32 v58, 0
    v_mov_b32 v59, 0
    s_mov_b32 s61, 0x3b124925
    s_mov_b32 s62, 0xbfb8aa3b
    s_mov_b64 s[88:89], -1
    s_mov_b64 s[90:91], -1
    s_mov_b64 s[92:93], -1
    s_mov_b64 s[94:95], -1
    buffer_load_dwordx4 v[32:35], v1, s[44:47], 0 offen offset:0 sc1
    buffer_load_dwordx4 v[36:39], v1, s[44:47], 0 offen offset:3584 sc1
    buffer_load_dwordx4 v[40:43], v1, s[44:47], s64 offen offset:0 sc1
    buffer_load_dwordx4 v[44:47], v1, s[44:47], s64 offen offset:3584 sc1
L_h2_53:
    s_sub_u32 s39, s39, 1
    s_cbranch_scc1 L_end
    s_mov_b64 exec, s[88:89]
    buffer_load_dwordx4 v[32:35], v1, s[44:47], 0 offen offset:0 sc1
    s_mov_b64 exec, s[90:91]
    buffer_load_dwordx4 v[36:39], v1, s[44:47], 0 offen offset:3584 sc1
    s_mov_b64 exec, s[92:93]
    buffer_load_dwordx4 v[40:43], v1, s[44:47], s64 offen offset:0 sc1
    s_mov_b64 exec, s[94:95]
    buffer_load_dwordx4 v[44:47], v1, s[44:47], s64 offen offset:3584 sc1
    s_mov_b64 exec, -1
    s_waitcnt vmcnt(4)
L_h2w_51:
    v_cmp_eq_u32 s[88:89], -1, v35
    v_cmp_eq_u32 s[90:91], -1, v39
    v_cmp_eq_u32 s[92:93], -1, v43
    v_cmp_eq_u32 s[94:95], -1, v47
    v_pk_add_f32 v[16:17], v[32:33], v[36:37]
    v_pk_add_f32 v[18:19], v[34:35], v[38:39]
    s_or_b64 vcc, s[88:89], s[90:91]
    s_or_b64 s[68:69], s[92:93], s[94:95]
    s_or_b64 vcc, vcc, s[68:69]
    s_cbranch_scc1 L_h2_53
    v_pk_add_f32 v[20:21], v[40:41], v[44:45]
    v_pk_add_f32 v[22:23], v[42:43], v[46:47]
    v_pk_add_f32 v[16:17], v[16:17], v[20:21]
    v_pk_add_f32 v[18:19], v[18:19], v[22:23]
    v_pk_fma_f32 v[16:17], v[16:17], v[70:71], v[78:79]
    v_pk_fma_f32 v[18:19], v[18:19], v[72:73], v[80:81]
    v_add_f32 v12, v16, v17
    v_mul_f32 v13, v16, v16
    v_add_f32 v12, v12, v18
    v_fmac_f32 v13, v17, v17
    v_add_f32 v12, v12, v19
    v_fmac_f32 v13, v18, v18
    v_fmac_f32 v13, v19, v19
    v_pk_mul_f32 v[20:21], v[16:17], v[74:75]
    v_pk_mul_f32 v[22:23], v[18:19], v[76:77]
    v_permlane32_swap_b32 v12, v13
    v_add_f32 v12, v12, v13
    v_cvt_pk_bf16_f32 v8, v20, v21
    v_cvt_pk_bf16_f32 v9, v22, v23
    v_add_f32_dpp v12, v12, v12 row_ror:8 row_mask:0xf bank_mask:0xf
    ds_write2_b32 v68, v8, v9 offset0:0 offset1:16
    v_cvt_pk_bf16_f32 v10, v16, v17
    v_add_f32_dpp v12, v12, v12 row_ror:4 row_mask:0xf bank_mask:0xf
    v_cvt_pk_bf16_f32 v11, v18, v19
    v_lshlrev_b32 v16, 16, v10
    v_add_f32_dpp v12, v12, v12 row_ror:2 row_mask:0xf bank_mask:0xf
    v_and_b32 v17, 0xffff0000, v10
    v_lshlrev_b32 v18, 16, v11
    v_add_f32_dpp v12, v12, v12 row_ror:1 row_mask:0xf bank_mask:0xf
    v_and_b32 v19, 0xffff0000, v11
    v_cmp_u_f32 vcc, v12, v12
    v_add_f32_dpp v12, v12, v12 row_bcast:15 row_mask:0xa bank_mask:0xf
    ds_write_b32 v3, v12
    s_cbranch_vccnz L_h2slow_54
L_h2ok_55:
    s_cmp_eq_u32 s36, 1
    s_waitcnt lgkmcnt(0)
    s_barrier
    ds_read_b128 v[20:23], v69
    ds_read_b128 v[8:11], v5
    ds_read_b128 v[24:27], v69 offset:576
    ds_read_b128 v[28:31], v69 offset:1152
    s_waitcnt vmcnt(0) lgkmcnt(3)
    v_smfmac_f32_16x16x64_bf16 v[52:55], v[20:23], v[88:95], v6
    ds_read_b128 v[32:35], v69 offset:1728
    v_smfmac_f32_16x16x64_bf16 v[56:59], v[20:23], v[144:151], v6
    ds_read_b128 v[36:39], v69 offset:2304
    s_waitcnt lgkmcnt(3)
    v_smfmac_f32_16x16x64_bf16 v[52:55], v[24:27], v[96:103], v6
    ds_read_b128 v[40:43], v69 offset:2880
    v_add_f32 v8, v8, v10
    v_add_f32 v9, v9, v11
    v_smfmac_f32_16x16x64_bf16 v[56:59], v[24:27], v[152:159], v6
    ds_read_b128 v[44:47], v69 offset:3456
    v_mul_f32 v8, s61, v8
    v_mul_f32 v9, s61, v9
    s_waitcnt lgkmcnt(4)
    v_smfmac_f32_16x16x64_bf16 v[52:55], v[28:31], v[104:111], v6
    v_fma_f32 v9, -v8, v8, v9
    v_max_f32 v9, 0, v9
    v_smfmac_f32_16x16x64_bf16 v[56:59], v[28:31], v[160:167], v6
    v_add_f32 v9, 0x3727c5ac, v9
    v_rsq_f32 v9, v9
    s_waitcnt lgkmcnt(3)
    v_smfmac_f32_16x16x64_bf16 v[52:55], v[32:35], v[112:119], v6
    v_mul_f32 v8, -v8, v9
    v_mul_f32 v14, s62, v9
    v_smfmac_f32_16x16x64_bf16 v[56:59], v[32:35], v[168:175], v6
    v_fma_f32 v12, v8, v82, v83
    v_fma_f32 v13, v8, v84, v85
    s_waitcnt lgkmcnt(2)
    v_smfmac_f32_16x16x64_bf16 v[52:55], v[36:39], v[120:127], v6
    v_mul_f32 v15, s62, v12
    v_smfmac_f32_16x16x64_bf16 v[56:59], v[36:39], v[176:183], v6
    s_waitcnt lgkmcnt(1)
    v_smfmac_f32_16x16x64_bf16 v[52:55], v[40:43], v[128:135], v6
    s_waitcnt lgkmcnt(0)
    v_smfmac_f32_16x16x64_bf16 v[52:55], v[44:47], v[136:143], v6
    ds_write_b128 v2, v[16:19]
    s_nop 0
    s_nop 0
    v_smfmac_f32_16x16x64_bf16 v[56:59], v[40:43], v[184:191], v6
    s_nop 0
    s_nop 0
    v_smfmac_f32_16x16x64_bf16 v[56:59], v[44:47], v[192:199], v6
    s_nop 0
    v_add_f32 v10, v52, v53
    v_fma_f32 v11, v10, v14, v15
    v_exp_f32 v11, v11
    v_fma_f32 v10, v10, v9, v12
    v_add_f32 v11, 1.0, v11
    v_rcp_f32 v11, v11
    v_mov_b64 v[52:53], 0
    v_mov_b64 v[54:55], 0
    v_mul_f32 v10, v10, v11
    v_add_f32 v11, v56, v57
    v_fma_f32 v11, v11, v9, v13
    v_mul_f32 v10, v10, v11
    v_cvt_pk_bf16_f32 v10, v10, v10
    ds_write_b16 v65, v10
    v_mov_b64 v[56:57], 0
    v_mov_b64 v[58:59], 0
    v_mov_b64 v[44:45], 0
    v_mov_b64 v[46:47], 0
    s_mov_b64 s[88:89], -1
    s_mov_b64 s[90:91], -1
    s_mov_b64 s[92:93], -1
    s_mov_b64 s[94:95], -1
    s_mov_b32 s95, 0
    s_waitcnt lgkmcnt(0)
    s_barrier
    ds_read_b128 v[8:11], v60
    ds_read_b128 v[12:15], v61
    ds_read_b128 v[16:19], v62
    ds_read_b128 v[20:23], v63
    s_waitcnt lgkmcnt(3)
    v_smfmac_f32_16x16x64_bf16 v[52:55], v[8:11], v[200:207], v6
    v_smfmac_f32_16x16x64_bf16 v[56:59], v[8:11], v[232:239], v6
    s_waitcnt lgkmcnt(2)
    v_smfmac_f32_16x16x64_bf16 v[52:55], v[12:15], v[208:215], v6
    v_smfmac_f32_16x16x64_bf16 v[56:59], v[12:15], v[240:247], v6
    s_waitcnt lgkmcnt(1)
    v_smfmac_f32_16x16x64_bf16 v[52:55], v[16:19], v[216:223], v6
    v_smfmac_f32_16x16x64_bf16 v[56:59], v[16:19], v[248:255], v6
    s_waitcnt lgkmcnt(0)
    v_smfmac_f32_16x16x64_bf16 v[52:55], v[20:23], v[224:231], v6
    ds_read_b32 v67, v67
    s_nop 4
    v_add_f32 v26, v56, v57
    v_add_f32 v27, v58, v59
    v_add_f32 v24, v52, v53
    v_add_f32 v25, v54, v55
    s_cbranch_scc0 L_sl_56
    buffer_store_dwordx4 v[24:27], v64, s[44:47], 0 offen
L_sd_57:
    s_cmp_lt_u32 s3, 32
    s_cbranch_scc0 L_fdone
    s_waitcnt vmcnt(0)
L_h3w_59:
    s_mov_b64 exec, s[88:89]
    buffer_load_dwordx4 v[32:35], v66, s[44:47], 0 offen sc1
    s_mov_b64 exec, s[90:91]
    buffer_load_dwordx4 v[36:39], v66, s[44:47], s63 offen sc1
    s_mov_b64 exec, s[92:93]
    buffer_load_dwordx4 v[40:43], v66, s[44:47], s65 offen sc1
    s_mov_b64 exec, s[94:95]
    buffer_load_dwordx4 v[44:47], v66, s[44:47], s96 offen sc1
    s_mov_b64 exec, -1
L_h3_60:
    s_sub_u32 s39, s39, 1
    s_cbranch_scc1 L_end
    s_mov_b64 exec, s[88:89]
    buffer_load_dwordx4 v[32:35], v66, s[44:47], 0 offen sc1
    s_mov_b64 exec, s[90:91]
    buffer_load_dwordx4 v[36:39], v66, s[44:47], s63 offen sc1
    s_mov_b64 exec, s[92:93]
    buffer_load_dwordx4 v[40:43], v66, s[44:47], s65 offen sc1
    s_mov_b64 exec, s[94:95]
    buffer_load_dwordx4 v[44:47], v66, s[44:47], s96 offen sc1
    s_mov_b64 exec, -1
    s_waitcnt vmcnt(4)
L_h3c_61:
    v_cmp_eq_u32 s[88:89], -1, v35
    v_cmp_eq_u32 s[90:91], -1, v39
    v_cmp_eq_u32 s[92:93], -1, v43
    v_cmp_eq_u32 s[94:95], -1, v47
    v_pk_add_f32 v[16:17], v[32:33], v[36:37]
    v_pk_add_f32 v[18:19], v[34:35], v[38:39]
    s_or_b64 vcc, s[88:89], s[90:91]
    s_or_b64 s[68:69], s[92:93], s[94:95]
    s_or_b64 vcc, vcc, s[68:69]
    s_cbranch_scc1 L_h3_60
    v_pk_add_f32 v[20:21], v[40:41], v[44:45]
    v_pk_add_f32 v[22:23], v[42:43], v[46:47]
    v_pk_add_f32 v[16:17], v[16:17], v[20:21]
    v_pk_add_f32 v[18:19], v[18:19], v[22:23]
    s_nop 0
    v_permlane32_swap_b32 v16, v17
    v_permlane32_swap_b32 v18, v19
    v_add_f32 v16, v16, v17
    v_add_f32 v18, v18, v19
    s_nop 1
    v_permlane16_swap_b32 v16, v18
    v_add_f32 v20, v16, v18
    s_nop 1
    v_add_f32_dpp v20, v20, v20 row_ror:8 row_mask:0xf bank_mask:0xf
    v_cmp_u_f32 vcc, v20, v20
    s_waitcnt lgkmcnt(0)
    v_fma_f32 v20, v20, v86, v67
    v_cvt_pk_bf16_f32 v20, v20, v20
    s_cbranch_vccnz L_h3slow_62
L_h3ok_63:
    buffer_store_short v20, v87, s[52:55], 0 offen
    s_endpgm
L_h1slow_47:
    s_sub_u32 s39, s39, 1
    s_cbranch_scc1 L_end
    s_waitcnt vmcnt(0)
    v_max3_u32 v14, v32, v33, v33
    v_max3_u32 v14, v14, v34, v35
    v_max3_u32 v14, v14, v36, v37
    v_max3_u32 v14, v14, v38, v39
    v_max3_u32 v14, v14, v40, v41
    v_max3_u32 v14, v14, v42, v43
    v_max3_u32 v14, v14, v44, v45
    v_max3_u32 v14, v14, v46, v47
    v_max3_u32 v14, v14, v48, v49
    v_max3_u32 v14, v14, v50, v51
    v_max3_u32 v14, v14, v52, v53
    v_max3_u32 v14, v14, v54, v55
    v_max3_u32 v14, v14, v56, v57
    v_max3_u32 v14, v14, v58, v59
    v_max3_u32 v14, v14, v60, v61
    v_max3_u32 v14, v14, v62, v63
    v_cmp_eq_u32 vcc, -1, v14
    s_cbranch_vccnz L_h1all_44
    s_cmp_eq_u32 s100, 1
    s_cbranch_scc1 L_h1ok_48
    s_mov_b32 s100, 1
    s_branch L_h1z_45
L_h2slow_54:
    s_sub_u32 s39, s39, 1
    s_cbranch_scc1 L_end
    s_waitcnt vmcnt(0)
    v_max3_u32 v14, v32, v33, v33
    v_max3_u32 v14, v14, v34, v35
    v_max3_u32 v14, v14, v36, v37
    v_max3_u32 v14, v14, v38, v39
    v_max3_u32 v14, v14, v40, v41
    v_max3_u32 v14, v14, v42, v43
    v_max3_u32 v14, v14, v44, v45
    v_max3_u32 v14, v14, v46, v47
    v_cmp_eq_u32 vcc, -1, v14
    s_cbranch_vccnz L_h2all_52
    s_cmp_eq_u32 s100, 2
    s_cbranch_scc1 L_h2ok_55
    s_mov_b32 s100, 2
    s_branch L_h2w_51
L_h3slow_62:
    s_sub_u32 s39, s39, 1
    s_cbranch_scc1 L_end
    s_waitcnt vmcnt(0)
    v_max3_u32 v14, v32, v33, v33
    v_max3_u32 v14, v14, v34, v35
    v_max3_u32 v14, v14, v36, v37
    v_max3_u32 v14, v14, v38, v39
    v_max3_u32 v14, v14, v40, v41
    v_max3_u32 v14, v14, v42, v43
    v_max3_u32 v14, v14, v44, v45
    v_max3_u32 v14, v14, v46, v47
    v_cmp_eq_u32 vcc, -1, v14
    s_cbranch_vccnz L_h3all_58
    s_cmp_eq_u32 s100, 3
    s_cbranch_scc1 L_h3ok_63
    s_mov_b32 s100, 3
    s_branch L_h3c_61
L_sl_41:
    buffer_store_dwordx4 v[8:11], v64, s[44:47], 0 offen sc1
    s_branch L_sd_42
L_sl_49:
    buffer_store_dword v68, v64, s[44:47], 0 offen sc1
    s_branch L_sd_50
L_h2all_52:
    buffer_load_dwordx4 v[32:35], v1, s[44:47], 0 offen offset:0 sc1
    buffer_load_dwordx4 v[36:39], v1, s[44:47], 0 offen offset:3584 sc1
    buffer_load_dwordx4 v[40:43], v1, s[44:47], s64 offen offset:0 sc1
    buffer_load_dwordx4 v[44:47], v1, s[44:47], s64 offen offset:3584 sc1
    s_waitcnt vmcnt(0)
    s_branch L_h2w_51
L_sl_56:
    buffer_store_dwordx4 v[24:27], v64, s[44:47], 0 offen sc1
    s_branch L_sd_57
L_h3all_58:
    s_mov_b64 s[88:89], -1
    s_mov_b64 s[90:91], -1
    s_mov_b64 s[92:93], -1
    s_mov_b64 s[94:95], -1
    s_mov_b32 s95, 0
    s_branch L_h3w_59
L_fdone:
    s_lshl_b32 s60, s33, 2
    s_add_u32 s60, s60, s31
    s_cmp_eq_u32 s60, 2
    s_cbranch_scc0 L_end
    v_cmp_eq_u32 vcc, 0, v0
    v_mov_b32 v8, s38
    s_nop 0
    v_cndmask_b32 v9, v7, v0, vcc
    buffer_store_dword v8, v9, s[44:47], 0 offen
L_end:
L_exit:
    s_endpgm
.section .rodata,"a"
.p2align 6
.amdhsa_kernel adaLN_cond__sliding_block_cached__swiglu_ffn__decode_kernel
  .amdhsa_next_free_vgpr 256
  .amdhsa_next_free_sgpr 102
  .amdhsa_accum_offset 256
  .amdhsa_group_segment_fixed_size 0
  .amdhsa_kernarg_size 112
  .amdhsa_user_sgpr_count 2
  .amdhsa_user_sgpr_kernarg_segment_ptr 1
  .amdhsa_system_sgpr_workgroup_id_x 1
  .amdhsa_float_denorm_mode_32 3
.end_amdhsa_kernel
```
